```python
import torch

def _softmax(x, axis=-1):
    return torch.softmax(x, dim=axis)
def _gelu(x):
    return torch.nn.functional.gelu(x, approximate="tanh")
def _silu(x):
    return torch.nn.functional.silu(x)
def _sigmoid(x):
    return torch.sigmoid(x)
def _layernorm(x, axis=-1, eps=1e-5):
    m = x.mean(dim=axis, keepdim=True)
    v = x.var(dim=axis, keepdim=True, unbiased=False)
    return (x - m) / torch.sqrt(v + eps)
def _scatter_add(tgt, idx, src, axis=0):
    return tgt.clone().index_add_(axis, idx, src)
def _segment_sum(src, seg, n):
    out = torch.zeros((n,) + src.shape[1:], dtype=src.dtype)
    return out.index_add_(0, seg, src)
def _pad(x, pw):
    flat = tuple(v for pair in reversed(pw) for v in pair)
    return torch.nn.functional.pad(x, flat)

kernel_name = 'sequential_preLN__spectral_gfnet__glu_gated_reglu__prompt'

def setup_inputs():

    _w = (lambda a: (lambda t: t.to(torch.bfloat16) if t.is_floating_point() else t)(torch.as_tensor(a)))
    def _A_setup():
        B, S, D = 1, 2048, 512
        Df = D // 2 + 1
        return {
            "x": _w((lambda *s: torch.randn(*s, dtype=torch.bfloat16) * 0.05)(B, S, D)),
            "w_r": _w((lambda *s: torch.randn(*s, dtype=torch.bfloat16) * 0.4)(S, Df) * 0.02),
            "w_i": _w((lambda *s: torch.randn(*s, dtype=torch.bfloat16) * 0.4)(S, Df) * 0.02),
        }
    _A_in = _A_setup()

    def _B_setup():
        B, S, D, F = 1, 2048, 512, 1792
        return {
            "x": _w((lambda *s: torch.randn(*s, dtype=torch.bfloat16) * 0.05)(B, S, D)),
            "W_gate": _w((lambda *s: torch.randn(*s, dtype=torch.bfloat16) * 0.2)(D, F) * (2.0 / D) ** 0.5),
            "W_up": _w((lambda *s: torch.randn(*s, dtype=torch.bfloat16) * 0.2)(D, F) * (2.0 / D) ** 0.5),
            "W_down": _w((lambda *s: torch.randn(*s, dtype=torch.bfloat16) * 0.2)(F, D) * (1.0 / F) ** 0.5),
        }
    _B_in = _B_setup()

    return {
        "A_x": _A_in["x"],
        "A_w_r": _A_in["w_r"],
        "A_w_i": _A_in["w_i"],
        "B_x": _B_in["x"],
        "B_W_gate": _B_in["W_gate"],
        "B_W_up": _B_in["W_up"],
        "B_W_down": _B_in["W_down"],
    }

def reference(A_x, A_w_r, A_w_i, B_x, B_W_gate, B_W_up, B_W_down):
    def _A_ref(x, w_r, w_i):
        B, S, D = x.shape
        X = (lambda x, axes=(-2,-1): torch.fft.rfft2(x.float(), dim=axes))(x, axes=(-2, -1))
        W = w_r + 1j * w_i
        X = X * W
        y = (lambda x, s, axes=(-2,-1): torch.fft.irfft2(x, s=s, dim=axes).to(torch.bfloat16))(X, (S, D), axes=(-2, -1))
        return y

    def _B_ref(x, W_gate, W_up, W_down):
        gate = torch.einsum("bsd,df->bsf", x, W_gate)
        up = torch.einsum("bsd,df->bsf", x, W_up)
        gate = gate * (lambda x, dt: x.to(dt))(gate > 0, gate.dtype)
        h = gate * up
        return torch.einsum("bsf,fd->bsd", h, W_down)

    x = A_x
    h = x + _A_ref(_layernorm(x, axis=-1), A_w_r, A_w_i)
    h2 = h + _B_ref(_layernorm(h, axis=-1), B_W_gate, B_W_up, B_W_down)
    return h2
```

```asm
; @launch grid=(256,1,1) block=(256,1,1) lds=163840
.amdgcn_target "amdgcn-amd-amdhsa--gfx950"
.text
.globl sequential_preLN__spectral_gfnet__glu_gated_reglu__prompt_kernel
.p2align 8
.type sequential_preLN__spectral_gfnet__glu_gated_reglu__prompt_kernel,@function
sequential_preLN__spectral_gfnet__glu_gated_reglu__prompt_kernel:
    s_cmp_ge_u32 s2, 0x100
    s_cbranch_scc1 KEND
    s_load_dwordx16 s[64:79], s[0:1], 0
    s_load_dwordx4 s[80:83], s[0:1], 64
    v_and_b32 v1, 63, v0
    v_lshrrev_b32 v2, 6, v0
    s_nop 0
    v_readfirstlane_b32 s3, v2
    s_getpc_b64 s[44:45]
CODE_HERE:
    s_lshr_b32 s4, s2, 3
    s_mul_i32 s4, s4, 0x400
    v_lshlrev_b32 v4, 6, v1
    v_add_u32 v4, s4, v4
    v_cmp_gt_u32 vcc, KEND-CODE_HERE, v4
    s_cmp_lg_u32 s3, 3
    s_cbranch_scc1 NOCPF_1
    s_nop 1
    s_and_b64 exec, vcc, 0xffff
    s_cbranch_execz NOCPF_1_R
    global_load_dword v60, v4, s[44:45]
NOCPF_1_R:
    s_mov_b64 exec, -1
NOCPF_1:
    v_and_b32 v2, 31, v1
    v_lshrrev_b32 v3, 5, v1
    v_lshlrev_b32 v12, 4, v1
    s_and_b32 s4, s2, 7
    s_lshr_b32 s5, s2, 6
    s_lshl_b32 s5, s5, 3
    s_add_u32 s32, s4, s5
    s_lshr_b32 s4, s2, 3
    s_and_b32 s33, s4, 7
    s_and_b32 s34, s3, 1
    s_lshr_b32 s35, s3, 1
    s_xor_b32 s36, s34, s35
    s_lshl_b32 s4, s35, 4
    s_lshl_b32 s5, s34, 3
    s_add_u32 s4, s4, s5
    s_lshl_b32 s4, s4, 5
    s_add_u32 s4, s4, s32
    s_lshl_b32 s37, s4, 10
    s_lshl_b32 s38, s3, 14
    s_lshl_b32 s4, s33, 5
    s_add_u32 s4, s4, 1
    v_add_u32 v4, s4, v2
    v_cvt_f32_u32 v15, v4
    v_mul_f32 v15, 0x3b000000, v15
    v_and_b32 v5, 1, v4
    v_mov_b32 v6, 0x80008000
    v_mul_lo_u32 v18, v5, v6
    s_lshl_b32 s4, s35, 7
    v_lshlrev_b32 v5, 3, v3
    v_add_u32 v5, s4, v5
    v_cvt_f32_u32 v5, v5
    s_mul_i32 s4, s34, 0x3e800000
    v_mov_b32 v6, s4
    v_fma_f32 v13, v15, v5, v6
    v_add_f32 v14, v13, v15
    v_add_f32 v16, v15, v15
    v_mul_f32 v17, 0x41200000, v15
    s_waitcnt lgkmcnt(0)
    s_mov_b32 s8, s64
    s_mov_b32 s9, s65
    s_mov_b32 s10, 0x200000
    s_mov_b32 s11, 0x20000
    s_add_u32 s84, s82, 0xf40000
    s_addc_u32 s85, s83, 0
    s_mov_b32 s86, 0x10000
    s_mov_b32 s87, 0x20000
    s_or_b32 s4, s2, s3
    s_cmp_lg_u32 s4, 0
    s_cbranch_scc1 INIT_2
    v_lshlrev_b32 v6, 8, v1
    v_mov_b32 v7, 0
    buffer_store_dword v7, v6, s[84:87], 0 offen sc1
    s_movk_i32 s4, 0x4000
    buffer_store_dword v7, v6, s[84:87], s4 offen sc1
INIT_2:
    v_lshrrev_b32 v4, 3, v1
    v_lshrrev_b32 v5, 2, v4
    v_lshlrev_b32 v5, 5, v5
    v_and_b32 v6, 3, v4
    v_add_u32 v5, v5, v6
    v_lshlrev_b32 v5, 15, v5
    v_lshrrev_b32 v6, 1, v4
    v_and_b32 v7, 7, v1
    v_xor_b32 v6, v6, v7
    v_lshl_add_u32 v21, v6, 4, v5
    v_xor_b32 v6, 4, v6
    v_lshl_add_u32 v23, v6, 4, v5
    v_add_u32 v23, 0x20000, v23
    s_lshl_b32 s38, s3, 11
    s_add_u32 s4, s37, 0
    s_add_u32 m0, s38, 0
    s_nop 0
    buffer_load_dwordx4 v21, s[8:11], s4 offen lds
    v_cos_f32 v8, v13
    v_cos_f32 v9, v14
    v_add_f32 v13, v13, v16
    v_add_f32 v14, v14, v16
    v_cvt_pk_bf16_f32 v64, v8, v9
    v_xor_b32 v96, v18, v64
    s_add_u32 s4, s37, 0
    s_add_u32 m0, s38, 0x400
    s_nop 0
    buffer_load_dwordx4 v23, s[8:11], s4 offen lds
    v_cos_f32 v10, v13
    v_cos_f32 v11, v14
    v_add_f32 v13, v13, v16
    v_add_f32 v14, v14, v16
    v_cvt_pk_bf16_f32 v65, v10, v11
    v_xor_b32 v97, v18, v65
    s_add_u32 s4, s37, 0x100
    s_add_u32 m0, s38, 0x4000
    s_nop 0
    buffer_load_dwordx4 v21, s[8:11], s4 offen lds
    v_cos_f32 v8, v13
    v_cos_f32 v9, v14
    v_add_f32 v13, v13, v16
    v_add_f32 v14, v14, v16
    v_cvt_pk_bf16_f32 v66, v8, v9
    v_xor_b32 v98, v18, v66
    s_add_u32 s4, s37, 0x100
    s_add_u32 m0, s38, 0x4400
    s_nop 0
    buffer_load_dwordx4 v23, s[8:11], s4 offen lds
    v_cos_f32 v10, v13
    v_cos_f32 v11, v14
    v_add_f32 v13, v13, v17
    v_add_f32 v14, v14, v17
    v_cvt_pk_bf16_f32 v67, v10, v11
    v_xor_b32 v99, v18, v67
    s_add_u32 s4, s37, 0x80
    s_add_u32 m0, s38, 0x2000
    s_nop 0
    buffer_load_dwordx4 v21, s[8:11], s4 offen lds
    v_cos_f32 v8, v13
    v_cos_f32 v9, v14
    v_add_f32 v13, v13, v16
    v_add_f32 v14, v14, v16
    v_cvt_pk_bf16_f32 v68, v8, v9
    v_xor_b32 v100, v18, v68
    s_add_u32 s4, s37, 0x80
    s_add_u32 m0, s38, 0x2400
    s_nop 0
    buffer_load_dwordx4 v23, s[8:11], s4 offen lds
    v_cos_f32 v10, v13
    v_cos_f32 v11, v14
    v_add_f32 v13, v13, v16
    v_add_f32 v14, v14, v16
    v_cvt_pk_bf16_f32 v69, v10, v11
    v_xor_b32 v101, v18, v69
    s_add_u32 s4, s37, 0x180
    s_add_u32 m0, s38, 0x6000
    s_nop 0
    buffer_load_dwordx4 v21, s[8:11], s4 offen lds
    v_cos_f32 v8, v13
    v_cos_f32 v9, v14
    v_add_f32 v13, v13, v16
    v_add_f32 v14, v14, v16
    v_cvt_pk_bf16_f32 v70, v8, v9
    v_xor_b32 v102, v18, v70
    s_add_u32 s4, s37, 0x180
    s_add_u32 m0, s38, 0x6400
    s_nop 0
    buffer_load_dwordx4 v23, s[8:11], s4 offen lds
    v_cos_f32 v10, v13
    v_cos_f32 v11, v14
    v_add_f32 v13, v13, v17
    v_add_f32 v14, v14, v17
    v_cvt_pk_bf16_f32 v71, v10, v11
    v_xor_b32 v103, v18, v71
    s_add_u32 s4, s37, 0x200
    s_add_u32 m0, s38, 0x8000
    s_nop 0
    buffer_load_dwordx4 v21, s[8:11], s4 offen lds
    v_cos_f32 v8, v13
    v_cos_f32 v9, v14
    v_add_f32 v13, v13, v16
    v_add_f32 v14, v14, v16
    v_cvt_pk_bf16_f32 v72, v8, v9
    v_xor_b32 v104, v18, v72
    s_add_u32 s4, s37, 0x200
    s_add_u32 m0, s38, 0x8400
    s_nop 0
    buffer_load_dwordx4 v23, s[8:11], s4 offen lds
    v_cos_f32 v10, v13
    v_cos_f32 v11, v14
    v_add_f32 v13, v13, v16
    v_add_f32 v14, v14, v16
    v_cvt_pk_bf16_f32 v73, v10, v11
    v_xor_b32 v105, v18, v73
    s_add_u32 s4, s37, 0x300
    s_add_u32 m0, s38, 0xc000
    s_nop 0
    buffer_load_dwordx4 v21, s[8:11], s4 offen lds
    v_cos_f32 v8, v13
    v_cos_f32 v9, v14
    v_add_f32 v13, v13, v16
    v_add_f32 v14, v14, v16
    v_cvt_pk_bf16_f32 v74, v8, v9
    v_xor_b32 v106, v18, v74
    s_add_u32 s4, s37, 0x300
    s_add_u32 m0, s38, 0xc400
    s_nop 0
    buffer_load_dwordx4 v23, s[8:11], s4 offen lds
    v_cos_f32 v10, v13
    v_cos_f32 v11, v14
    v_add_f32 v13, v13, v17
    v_add_f32 v14, v14, v17
    v_cvt_pk_bf16_f32 v75, v10, v11
    v_xor_b32 v107, v18, v75
    s_add_u32 s4, s37, 0x280
    s_add_u32 m0, s38, 0xa000
    s_nop 0
    buffer_load_dwordx4 v21, s[8:11], s4 offen lds
    v_cos_f32 v8, v13
    v_cos_f32 v9, v14
    v_add_f32 v13, v13, v16
    v_add_f32 v14, v14, v16
    v_cvt_pk_bf16_f32 v76, v8, v9
    v_xor_b32 v108, v18, v76
    s_add_u32 s4, s37, 0x280
    s_add_u32 m0, s38, 0xa400
    s_nop 0
    buffer_load_dwordx4 v23, s[8:11], s4 offen lds
    v_cos_f32 v10, v13
    v_cos_f32 v11, v14
    v_add_f32 v13, v13, v16
    v_add_f32 v14, v14, v16
    v_cvt_pk_bf16_f32 v77, v10, v11
    v_xor_b32 v109, v18, v77
    s_add_u32 s4, s37, 0x380
    s_add_u32 m0, s38, 0xe000
    s_nop 0
    buffer_load_dwordx4 v21, s[8:11], s4 offen lds
    v_cos_f32 v8, v13
    v_cos_f32 v9, v14
    v_add_f32 v13, v13, v16
    v_add_f32 v14, v14, v16
    v_cvt_pk_bf16_f32 v78, v8, v9
    v_xor_b32 v110, v18, v78
    s_add_u32 s4, s37, 0x380
    s_add_u32 m0, s38, 0xe400
    s_nop 0
    buffer_load_dwordx4 v23, s[8:11], s4 offen lds
    v_cos_f32 v10, v13
    v_cos_f32 v11, v14
    v_add_f32 v13, v13, v17
    v_add_f32 v14, v14, v17
    v_cvt_pk_bf16_f32 v79, v10, v11
    v_xor_b32 v111, v18, v79
    s_mov_b32 s92, s80
    s_mov_b32 s93, s81
    s_mov_b32 s94, 0x100
    s_mov_b32 s95, 0x20000
    s_mov_b32 s12, s66
    s_mov_b32 s13, s67
    s_mov_b32 s14, 0x101000
    s_mov_b32 s15, 0x20000
    s_mov_b32 s16, s68
    s_mov_b32 s17, s69
    s_mov_b32 s18, 0x101000
    s_mov_b32 s19, 0x20000
    s_lshr_b32 s5, s32, 3
    s_lshl_b32 s5, s5, 4
    s_and_b32 s6, s32, 1
    s_lshl_b32 s6, s6, 3
    s_add_u32 s5, s5, s6
    s_lshr_b32 s6, s32, 1
    s_and_b32 s6, s6, 3
    s_lshl_b32 s6, s6, 8
    s_add_u32 s5, s5, s6
    s_lshl_b32 s6, s3, 1
    s_add_u32 s5, s5, s6
    v_add_u32 v4, s5, v3
    v_bfe_u32 v5, v1, 4, 1
    v_lshl_add_u32 v4, v5, 10, v4
    v_bfe_u32 v5, v1, 2, 2
    v_lshl_add_u32 v4, v5, 6, v4
    s_movk_i32 s7, 0x202
    v_mul_lo_u32 v4, v4, s7
    v_and_b32 v5, 3, v1
    v_lshl_add_u32 v19, v5, 4, v4
    s_lshl_b32 s6, s33, 6
    s_add_u32 s6, s6, 2
    s_lshl_b32 s7, s3, 10
    s_mov_b32 s40, s6
    s_mov_b32 s41, s7
    v_cos_f32 v8, v13
    v_cos_f32 v9, v14
    v_add_f32 v13, v13, v16
    v_add_f32 v14, v14, v16
    v_cvt_pk_bf16_f32 v80, v8, v9
    v_xor_b32 v112, v18, v80
    v_cos_f32 v10, v13
    v_cos_f32 v11, v14
    v_add_f32 v13, v13, v16
    v_add_f32 v14, v14, v16
    v_cvt_pk_bf16_f32 v81, v10, v11
    v_xor_b32 v113, v18, v81
    v_cos_f32 v8, v13
    v_cos_f32 v9, v14
    v_add_f32 v13, v13, v16
    v_add_f32 v14, v14, v16
    v_cvt_pk_bf16_f32 v82, v8, v9
    v_xor_b32 v114, v18, v82
    v_cos_f32 v10, v13
    v_cos_f32 v11, v14
    v_add_f32 v13, v13, v17
    v_add_f32 v14, v14, v17
    v_cvt_pk_bf16_f32 v83, v10, v11
    v_xor_b32 v115, v18, v83
    v_cos_f32 v8, v13
    v_cos_f32 v9, v14
    v_add_f32 v13, v13, v16
    v_add_f32 v14, v14, v16
    v_cvt_pk_bf16_f32 v84, v8, v9
    v_xor_b32 v116, v18, v84
    v_cos_f32 v10, v13
    v_cos_f32 v11, v14
    v_add_f32 v13, v13, v16
    v_add_f32 v14, v14, v16
    v_cvt_pk_bf16_f32 v85, v10, v11
    v_xor_b32 v117, v18, v85
    v_cos_f32 v8, v13
    v_cos_f32 v9, v14
    v_add_f32 v13, v13, v16
    v_add_f32 v14, v14, v16
    v_cvt_pk_bf16_f32 v86, v8, v9
    v_xor_b32 v118, v18, v86
    v_cos_f32 v10, v13
    v_cos_f32 v11, v14
    v_add_f32 v13, v13, v17
    v_add_f32 v14, v14, v17
    v_cvt_pk_bf16_f32 v87, v10, v11
    v_xor_b32 v119, v18, v87
    v_cos_f32 v8, v13
    v_cos_f32 v9, v14
    v_add_f32 v13, v13, v16
    v_add_f32 v14, v14, v16
    v_cvt_pk_bf16_f32 v88, v8, v9
    v_xor_b32 v120, v18, v88
    v_cos_f32 v10, v13
    v_cos_f32 v11, v14
    v_add_f32 v13, v13, v16
    v_add_f32 v14, v14, v16
    v_cvt_pk_bf16_f32 v89, v10, v11
    v_xor_b32 v121, v18, v89
    v_cos_f32 v8, v13
    v_cos_f32 v9, v14
    v_add_f32 v13, v13, v16
    v_add_f32 v14, v14, v16
    v_cvt_pk_bf16_f32 v90, v8, v9
    v_xor_b32 v122, v18, v90
    v_cos_f32 v10, v13
    v_cos_f32 v11, v14
    v_add_f32 v13, v13, v17
    v_add_f32 v14, v14, v17
    v_cvt_pk_bf16_f32 v91, v10, v11
    v_xor_b32 v123, v18, v91
    v_cos_f32 v8, v13
    v_cos_f32 v9, v14
    v_add_f32 v13, v13, v16
    v_add_f32 v14, v14, v16
    v_cvt_pk_bf16_f32 v92, v8, v9
    v_xor_b32 v124, v18, v92
    v_cos_f32 v10, v13
    v_cos_f32 v11, v14
    v_add_f32 v13, v13, v16
    v_add_f32 v14, v14, v16
    v_cvt_pk_bf16_f32 v93, v10, v11
    v_xor_b32 v125, v18, v93
    v_cos_f32 v8, v13
    v_cos_f32 v9, v14
    v_add_f32 v13, v13, v16
    v_add_f32 v14, v14, v16
    v_cvt_pk_bf16_f32 v94, v8, v9
    v_xor_b32 v126, v18, v94
    v_cos_f32 v10, v13
    v_cos_f32 v11, v14
    v_add_f32 v13, v13, v17
    v_add_f32 v14, v14, v17
    v_cvt_pk_bf16_f32 v95, v10, v11
    v_xor_b32 v127, v18, v95
    s_mov_b32 s20, s82
    s_mov_b32 s21, s83
    s_mov_b32 s22, 0x200000
    s_mov_b32 s23, 0x20000
    s_add_u32 s24, s82, 0x200000
    s_addc_u32 s25, s83, 0
    s_mov_b32 s26, 0x200000
    s_mov_b32 s27, 0x20000
    s_add_u32 s28, s82, 0xf00000
    s_addc_u32 s29, s83, 0
    s_mov_b32 s30, 0x2000
    s_mov_b32 s31, 0x20000
    v_bfe_u32 v4, v2, 1, 3
    v_xor_b32 v4, v4, v3
    v_lshlrev_b32 v4, 4, v4
    v_lshl_add_u32 v4, v2, 7, v4
    s_lshl_b32 s4, s35, 14
    s_lshl_b32 s5, s36, 12
    s_or_b32 s4, s4, s5
    v_add_u32 v4, s4, v4
    v_xor_b32 v32, 0, v4
    v_xor_b32 v40, 0x1000, v4
    v_xor_b32 v33, 32, v4
    v_xor_b32 v41, 0x1020, v4
    v_xor_b32 v34, 64, v4
    v_xor_b32 v42, 0x1040, v4
    v_xor_b32 v35, 0x60, v4
    v_xor_b32 v43, 0x1060, v4
    v_mov_b32 v24, 0
    v_mov_b32 v25, 0
    v_and_b32 v5, 15, v1
    v_bfe_u32 v6, v1, 4, 1
    v_cmp_eq_u32 vcc, v5, v6
    v_mov_b32 v5, 0
    v_mov_b32 v6, 0x3f803f80
    v_cndmask_b32 v204, v5, v6, vcc
    v_mov_b32 v205, v204
    v_mov_b32 v206, v204
    v_mov_b32 v207, v204
    s_add_u32 m0, s41, 0x14a00
    s_nop 0
    buffer_load_dwordx4 v19, s[12:15], s40 offen lds
    s_add_u32 m0, s41, 0x15a00
    s_nop 0
    buffer_load_dwordx4 v19, s[16:19], s40 offen lds
    s_waitcnt vmcnt(14)
    s_or_b32 s4, s2, s3
    s_cmp_lg_u32 s4, 0
    s_cbranch_scc1 INIT2_3
    v_mov_b32 v4, 0
    v_mov_b32 v5, 1
    s_mov_b64 exec, 1
    buffer_store_dword v5, v4, s[92:95], 0 offen sc1
    s_mov_b64 exec, -1
INIT2_3:
    s_barrier
    ds_read_b128 v[160:163], v32 offset:0
    ds_read_b128 v[164:167], v40 offset:0
    ds_read_b128 v[168:171], v33 offset:0
    ds_read_b128 v[172:175], v41 offset:0
    s_waitcnt lgkmcnt(2)
    v_mfma_f32_32x32x16_bf16 v[128:143], v[160:163], v[64:67], 0
    v_lshlrev_b32 v26, 16, v160
    v_and_b32 v27, 0xffff0000, v160
    v_fmac_f32 v24, v26, v26
    v_fmac_f32 v25, v27, v27
    v_lshlrev_b32 v28, 16, v161
    v_and_b32 v29, 0xffff0000, v161
    v_fmac_f32 v24, v28, v28
    v_fmac_f32 v25, v29, v29
    v_mfma_f32_16x16x32_bf16 v[200:203], v[160:163], v[204:207], 0
    v_mfma_f32_32x32x16_bf16 v[144:159], v[164:167], v[64:67], 0
    v_lshlrev_b32 v26, 16, v162
    v_and_b32 v27, 0xffff0000, v162
    v_fmac_f32 v24, v26, v26
    v_fmac_f32 v25, v27, v27
    v_lshlrev_b32 v28, 16, v163
    v_and_b32 v29, 0xffff0000, v163
    v_fmac_f32 v24, v28, v28
    v_fmac_f32 v25, v29, v29
    ds_read_b128 v[160:163], v34 offset:0
    ds_read_b128 v[164:167], v42 offset:0
    s_waitcnt lgkmcnt(2)
    v_mfma_f32_32x32x16_bf16 v[128:143], v[168:171], v[68:71], v[128:143]
    v_lshlrev_b32 v26, 16, v168
    v_and_b32 v27, 0xffff0000, v168
    v_fmac_f32 v24, v26, v26
    v_fmac_f32 v25, v27, v27
    v_lshlrev_b32 v28, 16, v169
    v_and_b32 v29, 0xffff0000, v169
    v_fmac_f32 v24, v28, v28
    v_fmac_f32 v25, v29, v29
    v_mfma_f32_16x16x32_bf16 v[200:203], v[168:171], v[204:207], v[200:203]
    v_mfma_f32_32x32x16_bf16 v[144:159], v[172:175], v[68:71], v[144:159]
    v_lshlrev_b32 v26, 16, v170
    v_and_b32 v27, 0xffff0000, v170
    v_fmac_f32 v24, v26, v26
    v_fmac_f32 v25, v27, v27
    v_lshlrev_b32 v28, 16, v171
    v_and_b32 v29, 0xffff0000, v171
    v_fmac_f32 v24, v28, v28
    v_fmac_f32 v25, v29, v29
    ds_read_b128 v[168:171], v35 offset:0
    ds_read_b128 v[172:175], v43 offset:0
    s_waitcnt lgkmcnt(2)
    v_mfma_f32_32x32x16_bf16 v[128:143], v[160:163], v[72:75], v[128:143]
    v_lshlrev_b32 v26, 16, v160
    v_and_b32 v27, 0xffff0000, v160
    v_fmac_f32 v24, v26, v26
    v_fmac_f32 v25, v27, v27
    v_lshlrev_b32 v28, 16, v161
    v_and_b32 v29, 0xffff0000, v161
    v_fmac_f32 v24, v28, v28
    v_fmac_f32 v25, v29, v29
    v_mfma_f32_16x16x32_bf16 v[200:203], v[160:163], v[204:207], v[200:203]
    v_mfma_f32_32x32x16_bf16 v[144:159], v[164:167], v[72:75], v[144:159]
    v_lshlrev_b32 v26, 16, v162
    v_and_b32 v27, 0xffff0000, v162
    v_fmac_f32 v24, v26, v26
    v_fmac_f32 v25, v27, v27
    v_lshlrev_b32 v28, 16, v163
    v_and_b32 v29, 0xffff0000, v163
    v_fmac_f32 v24, v28, v28
    v_fmac_f32 v25, v29, v29
    s_waitcnt vmcnt(10)
    s_barrier
    ds_read_b128 v[160:163], v32 offset:8192
    ds_read_b128 v[164:167], v40 offset:8192
    s_waitcnt lgkmcnt(2)
    v_mfma_f32_32x32x16_bf16 v[128:143], v[168:171], v[76:79], v[128:143]
    v_lshlrev_b32 v26, 16, v168
    v_and_b32 v27, 0xffff0000, v168
    v_fmac_f32 v24, v26, v26
    v_fmac_f32 v25, v27, v27
    v_lshlrev_b32 v28, 16, v169
    v_and_b32 v29, 0xffff0000, v169
    v_fmac_f32 v24, v28, v28
    v_fmac_f32 v25, v29, v29
    v_mfma_f32_16x16x32_bf16 v[200:203], v[168:171], v[204:207], v[200:203]
    v_mfma_f32_32x32x16_bf16 v[144:159], v[172:175], v[76:79], v[144:159]
    v_lshlrev_b32 v26, 16, v170
    v_and_b32 v27, 0xffff0000, v170
    v_fmac_f32 v24, v26, v26
    v_fmac_f32 v25, v27, v27
    v_lshlrev_b32 v28, 16, v171
    v_and_b32 v29, 0xffff0000, v171
    v_fmac_f32 v24, v28, v28
    v_fmac_f32 v25, v29, v29
    ds_read_b128 v[168:171], v33 offset:8192
    ds_read_b128 v[172:175], v41 offset:8192
    s_waitcnt lgkmcnt(2)
    v_mfma_f32_32x32x16_bf16 v[128:143], v[160:163], v[80:83], v[128:143]
    v_lshlrev_b32 v26, 16, v160
    v_and_b32 v27, 0xffff0000, v160
    v_fmac_f32 v24, v26, v26
    v_fmac_f32 v25, v27, v27
    v_lshlrev_b32 v28, 16, v161
    v_and_b32 v29, 0xffff0000, v161
    v_fmac_f32 v24, v28, v28
    v_fmac_f32 v25, v29, v29
    v_mfma_f32_16x16x32_bf16 v[200:203], v[160:163], v[204:207], v[200:203]
    v_mfma_f32_32x32x16_bf16 v[144:159], v[164:167], v[80:83], v[144:159]
    v_lshlrev_b32 v26, 16, v162
    v_and_b32 v27, 0xffff0000, v162
    v_fmac_f32 v24, v26, v26
    v_fmac_f32 v25, v27, v27
    v_lshlrev_b32 v28, 16, v163
    v_and_b32 v29, 0xffff0000, v163
    v_fmac_f32 v24, v28, v28
    v_fmac_f32 v25, v29, v29
    ds_read_b128 v[160:163], v34 offset:8192
    ds_read_b128 v[164:167], v42 offset:8192
    s_waitcnt lgkmcnt(2)
    v_mfma_f32_32x32x16_bf16 v[128:143], v[168:171], v[84:87], v[128:143]
    v_lshlrev_b32 v26, 16, v168
    v_and_b32 v27, 0xffff0000, v168
    v_fmac_f32 v24, v26, v26
    v_fmac_f32 v25, v27, v27
    v_lshlrev_b32 v28, 16, v169
    v_and_b32 v29, 0xffff0000, v169
    v_fmac_f32 v24, v28, v28
    v_fmac_f32 v25, v29, v29
    v_mfma_f32_16x16x32_bf16 v[200:203], v[168:171], v[204:207], v[200:203]
    v_mfma_f32_32x32x16_bf16 v[144:159], v[172:175], v[84:87], v[144:159]
    v_lshlrev_b32 v26, 16, v170
    v_and_b32 v27, 0xffff0000, v170
    v_fmac_f32 v24, v26, v26
    v_fmac_f32 v25, v27, v27
    v_lshlrev_b32 v28, 16, v171
    v_and_b32 v29, 0xffff0000, v171
    v_fmac_f32 v24, v28, v28
    v_fmac_f32 v25, v29, v29
    ds_read_b128 v[168:171], v35 offset:8192
    ds_read_b128 v[172:175], v43 offset:8192
    s_waitcnt lgkmcnt(2)
    v_mfma_f32_32x32x16_bf16 v[128:143], v[160:163], v[88:91], v[128:143]
    v_lshlrev_b32 v26, 16, v160
    v_and_b32 v27, 0xffff0000, v160
    v_fmac_f32 v24, v26, v26
    v_fmac_f32 v25, v27, v27
    v_lshlrev_b32 v28, 16, v161
    v_and_b32 v29, 0xffff0000, v161
    v_fmac_f32 v24, v28, v28
    v_fmac_f32 v25, v29, v29
    v_mfma_f32_16x16x32_bf16 v[200:203], v[160:163], v[204:207], v[200:203]
    v_mfma_f32_32x32x16_bf16 v[144:159], v[164:167], v[88:91], v[144:159]
    v_lshlrev_b32 v26, 16, v162
    v_and_b32 v27, 0xffff0000, v162
    v_fmac_f32 v24, v26, v26
    v_fmac_f32 v25, v27, v27
    v_lshlrev_b32 v28, 16, v163
    v_and_b32 v29, 0xffff0000, v163
    v_fmac_f32 v24, v28, v28
    v_fmac_f32 v25, v29, v29
    s_lshl_b32 s4, s36, 10
    s_lshl_b32 s5, s35, 3
    s_add_u32 s4, s4, s5
    s_add_u32 s4, s4, 0x14000
    v_lshlrev_b32 v4, 5, v2
    v_lshl_add_u32 v208, v3, 2, v4
    v_add_u32 v208, s4, v208
    s_lshl_b32 s4, s36, 10
    s_add_u32 s4, s4, 0x14000
    v_add_u32 v215, s4, v4
    s_lshl_b32 s5, s35, 2
    s_add_u32 s4, s4, s5
    s_add_u32 s4, s4, 16
    v_and_b32 v6, 15, v1
    v_lshlrev_b32 v7, 9, v6
    v_lshrrev_b32 v10, 4, v1
    v_lshl_add_u32 v7, v10, 7, v7
    v_add_u32 v209, s4, v7
    v_cmp_gt_u32 s[98:99], 2, v6
    s_lshl_b32 s4, s3, 12
    s_add_u32 s4, s4, 0x10000
    v_add_u32 v210, s4, v12
    v_xor_b32 v211, 0x2000, v210
    v_lshlrev_b32 v8, 9, v3
    v_bfe_u32 v9, v1, 2, 2
    v_lshl_add_u32 v8, v9, 6, v8
    v_bfe_u32 v9, v1, 4, 1
    v_lshl_add_u32 v8, v9, 5, v8
    v_and_b32 v9, 3, v1
    v_lshl_add_u32 v8, v9, 3, v8
    s_lshl_b32 s4, s3, 10
    s_add_u32 s4, s4, 0x14a00
    v_add_u32 v212, s4, v8
    v_lshlrev_b32 v10, 8, v2
    s_lshl_b32 s4, s3, 1
    v_add_u32 v11, s4, v3
    v_and_b32 v9, 3, v2
    v_lshlrev_b32 v9, 1, v9
    v_xor_b32 v9, v9, v11
    v_lshl_add_u32 v213, v9, 4, v10
    v_add_u32 v213, 0x16a00, v213
    v_xor_b32 v214, 16, v213
    s_lshl_b32 s4, s3, 7
    s_add_u32 s4, s4, 0x14800
    v_lshlrev_b32 v6, 2, v2
    v_add_u32 v216, s4, v6
    v_lshlrev_b32 v7, 4, v3
    v_add_u32 v217, s4, v7
    v_bfe_u32 v8, v2, 2, 1
    v_lshlrev_b32 v8, 5, v8
    v_lshrrev_b32 v9, 3, v2
    v_lshl_add_u32 v8, v9, 2, v8
    v_and_b32 v9, 3, v2
    v_add_u32 v8, v8, v9
    s_lshl_b32 s4, s36, 4
    v_add_u32 v8, s4, v8
    s_lshl_b32 s4, s32, 6
    v_add_u32 v8, s4, v8
    v_lshlrev_b32 v218, 2, v8
    s_lshl_b32 s4, s36, 1
    v_lshlrev_b32 v4, 2, v3
    v_add_u32 v4, s4, v4
    v_and_b32 v5, 7, v2
    v_xor_b32 v4, v4, v5
    v_lshlrev_b32 v4, 4, v4
    v_lshl_add_u32 v4, v2, 7, v4
    s_lshl_b32 s4, s34, 12
    s_add_u32 s4, s4, 0x18a00
    v_add_u32 v219, s4, v4
    v_xor_b32 v220, 16, v219
    v_lshrrev_b32 v6, 3, v1
    v_and_b32 v7, 7, v1
    v_xor_b32 v8, v6, v7
    v_lshlrev_b32 v8, 4, v8
    v_lshl_add_u32 v8, v6, 7, v8
    s_lshl_b32 s4, s3, 11
    v_add_u32 v8, s4, v8
    v_add_u32 v221, 0x18a00, v8
    v_add_u32 v222, 0x16a00, v8
    s_and_b32 s4, s3, 1
    s_lshl_b32 s4, s4, 4
    v_add_u32 v4, s4, v6
    v_lshlrev_b32 v4, 13, v4
    v_lshl_add_u32 v223, v7, 4, v4
    s_lshl_b32 s45, s33, 18
    s_lshr_b32 s5, s3, 1
    s_lshl_b32 s5, s5, 12
    s_add_u32 s45, s45, s5
    s_lshl_b32 s5, s32, 7
    s_add_u32 s45, s45, s5
    s_add_u32 s46, s45, 0x10000
    v_lshrrev_b32 v5, 1, v6
    s_lshl_b32 s6, s3, 3
    v_add_u32 v5, s6, v5
    v_lshlrev_b32 v5, 13, v5
    v_and_b32 v11, 1, v6
    v_lshl_add_u32 v5, v11, 12, v5
    v_lshl_add_u32 v224, v7, 4, v5
    s_lshl_b32 s47, s33, 18
    s_lshl_b32 s7, s32, 7
    s_add_u32 s47, s47, s7
    s_add_u32 s43, s47, 0x8000
    s_waitcnt vmcnt(6)
    s_barrier
    ds_read_b128 v[160:163], v32 offset:32768
    ds_read_b128 v[164:167], v40 offset:32768
    s_waitcnt lgkmcnt(2)
    v_mfma_f32_32x32x16_bf16 v[128:143], v[168:171], v[92:95], v[128:143]
    v_lshlrev_b32 v26, 16, v168
    v_and_b32 v27, 0xffff0000, v168
    v_fmac_f32 v24, v26, v26
    v_fmac_f32 v25, v27, v27
    v_lshlrev_b32 v28, 16, v169
    v_and_b32 v29, 0xffff0000, v169
    v_fmac_f32 v24, v28, v28
    v_fmac_f32 v25, v29, v29
    v_mfma_f32_16x16x32_bf16 v[200:203], v[168:171], v[204:207], v[200:203]
    v_mfma_f32_32x32x16_bf16 v[144:159], v[172:175], v[92:95], v[144:159]
    v_lshlrev_b32 v26, 16, v170
    v_and_b32 v27, 0xffff0000, v170
    v_fmac_f32 v24, v26, v26
    v_fmac_f32 v25, v27, v27
    v_lshlrev_b32 v28, 16, v171
    v_and_b32 v29, 0xffff0000, v171
    v_fmac_f32 v24, v28, v28
    v_fmac_f32 v25, v29, v29
    ds_read_b128 v[168:171], v33 offset:32768
    ds_read_b128 v[172:175], v41 offset:32768
    s_waitcnt lgkmcnt(2)
    v_mfma_f32_32x32x16_bf16 v[128:143], v[160:163], v[96:99], v[128:143]
    v_lshlrev_b32 v26, 16, v160
    v_and_b32 v27, 0xffff0000, v160
    v_fmac_f32 v24, v26, v26
    v_fmac_f32 v25, v27, v27
    v_lshlrev_b32 v28, 16, v161
    v_and_b32 v29, 0xffff0000, v161
    v_fmac_f32 v24, v28, v28
    v_fmac_f32 v25, v29, v29
    v_mfma_f32_16x16x32_bf16 v[200:203], v[160:163], v[204:207], v[200:203]
    v_mfma_f32_32x32x16_bf16 v[144:159], v[164:167], v[96:99], v[144:159]
    v_lshlrev_b32 v26, 16, v162
    v_and_b32 v27, 0xffff0000, v162
    v_fmac_f32 v24, v26, v26
    v_fmac_f32 v25, v27, v27
    v_lshlrev_b32 v28, 16, v163
    v_and_b32 v29, 0xffff0000, v163
    v_fmac_f32 v24, v28, v28
    v_fmac_f32 v25, v29, v29
    ds_read_b128 v[160:163], v34 offset:32768
    ds_read_b128 v[164:167], v42 offset:32768
    s_waitcnt lgkmcnt(2)
    v_mfma_f32_32x32x16_bf16 v[128:143], v[168:171], v[100:103], v[128:143]
    v_lshlrev_b32 v26, 16, v168
    v_and_b32 v27, 0xffff0000, v168
    v_fmac_f32 v24, v26, v26
    v_fmac_f32 v25, v27, v27
    v_lshlrev_b32 v28, 16, v169
    v_and_b32 v29, 0xffff0000, v169
    v_fmac_f32 v24, v28, v28
    v_fmac_f32 v25, v29, v29
    v_mfma_f32_16x16x32_bf16 v[200:203], v[168:171], v[204:207], v[200:203]
    v_mfma_f32_32x32x16_bf16 v[144:159], v[172:175], v[100:103], v[144:159]
    v_lshlrev_b32 v26, 16, v170
    v_and_b32 v27, 0xffff0000, v170
    v_fmac_f32 v24, v26, v26
    v_fmac_f32 v25, v27, v27
    v_lshlrev_b32 v28, 16, v171
    v_and_b32 v29, 0xffff0000, v171
    v_fmac_f32 v24, v28, v28
    v_fmac_f32 v25, v29, v29
    ds_read_b128 v[168:171], v35 offset:32768
    ds_read_b128 v[172:175], v43 offset:32768
    s_waitcnt lgkmcnt(2)
    v_mfma_f32_32x32x16_bf16 v[128:143], v[160:163], v[104:107], v[128:143]
    v_lshlrev_b32 v26, 16, v160
    v_and_b32 v27, 0xffff0000, v160
    v_fmac_f32 v24, v26, v26
    v_fmac_f32 v25, v27, v27
    v_lshlrev_b32 v28, 16, v161
    v_and_b32 v29, 0xffff0000, v161
    v_fmac_f32 v24, v28, v28
    v_fmac_f32 v25, v29, v29
    v_mfma_f32_16x16x32_bf16 v[200:203], v[160:163], v[204:207], v[200:203]
    v_mfma_f32_32x32x16_bf16 v[144:159], v[164:167], v[104:107], v[144:159]
    v_lshlrev_b32 v26, 16, v162
    v_and_b32 v27, 0xffff0000, v162
    v_fmac_f32 v24, v26, v26
    v_fmac_f32 v25, v27, v27
    v_lshlrev_b32 v28, 16, v163
    v_and_b32 v29, 0xffff0000, v163
    v_fmac_f32 v24, v28, v28
    v_fmac_f32 v25, v29, v29
    s_waitcnt vmcnt(2)
    s_barrier
    ds_read_b128 v[160:163], v32 offset:40960
    ds_read_b128 v[164:167], v40 offset:40960
    s_waitcnt lgkmcnt(2)
    v_mfma_f32_32x32x16_bf16 v[128:143], v[168:171], v[108:111], v[128:143]
    v_lshlrev_b32 v26, 16, v168
    v_and_b32 v27, 0xffff0000, v168
    v_fmac_f32 v24, v26, v26
    v_fmac_f32 v25, v27, v27
    v_lshlrev_b32 v28, 16, v169
    v_and_b32 v29, 0xffff0000, v169
    v_fmac_f32 v24, v28, v28
    v_fmac_f32 v25, v29, v29
    v_mfma_f32_16x16x32_bf16 v[200:203], v[168:171], v[204:207], v[200:203]
    v_mfma_f32_32x32x16_bf16 v[144:159], v[172:175], v[108:111], v[144:159]
    v_lshlrev_b32 v26, 16, v170
    v_and_b32 v27, 0xffff0000, v170
    v_fmac_f32 v24, v26, v26
    v_fmac_f32 v25, v27, v27
    v_lshlrev_b32 v28, 16, v171
    v_and_b32 v29, 0xffff0000, v171
    v_fmac_f32 v24, v28, v28
    v_fmac_f32 v25, v29, v29
    ds_read_b128 v[168:171], v33 offset:40960
    ds_read_b128 v[172:175], v41 offset:40960
    s_waitcnt lgkmcnt(2)
    v_mfma_f32_32x32x16_bf16 v[128:143], v[160:163], v[112:115], v[128:143]
    v_lshlrev_b32 v26, 16, v160
    v_and_b32 v27, 0xffff0000, v160
    v_fmac_f32 v24, v26, v26
    v_fmac_f32 v25, v27, v27
    v_lshlrev_b32 v28, 16, v161
    v_and_b32 v29, 0xffff0000, v161
    v_fmac_f32 v24, v28, v28
    v_fmac_f32 v25, v29, v29
    v_mfma_f32_16x16x32_bf16 v[200:203], v[160:163], v[204:207], v[200:203]
    v_mfma_f32_32x32x16_bf16 v[144:159], v[164:167], v[112:115], v[144:159]
    v_lshlrev_b32 v26, 16, v162
    v_and_b32 v27, 0xffff0000, v162
    v_fmac_f32 v24, v26, v26
    v_fmac_f32 v25, v27, v27
    v_lshlrev_b32 v28, 16, v163
    v_and_b32 v29, 0xffff0000, v163
    v_fmac_f32 v24, v28, v28
    v_fmac_f32 v25, v29, v29
    ds_read_b128 v[160:163], v34 offset:40960
    ds_read_b128 v[164:167], v42 offset:40960
    s_waitcnt lgkmcnt(2)
    v_mfma_f32_32x32x16_bf16 v[128:143], v[168:171], v[116:119], v[128:143]
    v_lshlrev_b32 v26, 16, v168
    v_and_b32 v27, 0xffff0000, v168
    v_fmac_f32 v24, v26, v26
    v_fmac_f32 v25, v27, v27
    v_lshlrev_b32 v28, 16, v169
    v_and_b32 v29, 0xffff0000, v169
    v_fmac_f32 v24, v28, v28
    v_fmac_f32 v25, v29, v29
    v_mfma_f32_16x16x32_bf16 v[200:203], v[168:171], v[204:207], v[200:203]
    v_mfma_f32_32x32x16_bf16 v[144:159], v[172:175], v[116:119], v[144:159]
    v_lshlrev_b32 v26, 16, v170
    v_and_b32 v27, 0xffff0000, v170
    v_fmac_f32 v24, v26, v26
    v_fmac_f32 v25, v27, v27
    v_lshlrev_b32 v28, 16, v171
    v_and_b32 v29, 0xffff0000, v171
    v_fmac_f32 v24, v28, v28
    v_fmac_f32 v25, v29, v29
    ds_read_b128 v[168:171], v35 offset:40960
    ds_read_b128 v[172:175], v43 offset:40960
    s_waitcnt lgkmcnt(2)
    v_mfma_f32_32x32x16_bf16 v[128:143], v[160:163], v[120:123], v[128:143]
    v_lshlrev_b32 v26, 16, v160
    v_and_b32 v27, 0xffff0000, v160
    v_fmac_f32 v24, v26, v26
    v_fmac_f32 v25, v27, v27
    v_lshlrev_b32 v28, 16, v161
    v_and_b32 v29, 0xffff0000, v161
    v_fmac_f32 v24, v28, v28
    v_fmac_f32 v25, v29, v29
    v_mfma_f32_16x16x32_bf16 v[200:203], v[160:163], v[204:207], v[200:203]
    v_mfma_f32_32x32x16_bf16 v[144:159], v[164:167], v[120:123], v[144:159]
    v_lshlrev_b32 v26, 16, v162
    v_and_b32 v27, 0xffff0000, v162
    v_fmac_f32 v24, v26, v26
    v_fmac_f32 v25, v27, v27
    v_lshlrev_b32 v28, 16, v163
    v_and_b32 v29, 0xffff0000, v163
    v_fmac_f32 v24, v28, v28
    v_fmac_f32 v25, v29, v29
    s_waitcnt lgkmcnt(0)
    v_mfma_f32_32x32x16_bf16 v[128:143], v[168:171], v[124:127], v[128:143]
    v_lshlrev_b32 v26, 16, v168
    v_and_b32 v27, 0xffff0000, v168
    v_fmac_f32 v24, v26, v26
    v_fmac_f32 v25, v27, v27
    v_lshlrev_b32 v28, 16, v169
    v_and_b32 v29, 0xffff0000, v169
    v_fmac_f32 v24, v28, v28
    v_fmac_f32 v25, v29, v29
    v_mfma_f32_16x16x32_bf16 v[200:203], v[168:171], v[204:207], v[200:203]
    v_mfma_f32_32x32x16_bf16 v[144:159], v[172:175], v[124:127], v[144:159]
    v_lshlrev_b32 v26, 16, v170
    v_and_b32 v27, 0xffff0000, v170
    v_fmac_f32 v24, v26, v26
    v_fmac_f32 v25, v27, v27
    v_lshlrev_b32 v28, 16, v171
    v_and_b32 v29, 0xffff0000, v171
    v_fmac_f32 v24, v28, v28
    v_fmac_f32 v25, v29, v29
    v_mov_b32 v10, 0
    buffer_load_dword v30, v10, s[92:95], 0 offen sc1
    s_waitcnt vmcnt(1)
    ds_read_b64_tr_b16 v[48:49], v212 offset:0
    ds_read_b64_tr_b16 v[50:51], v212 offset:4096
    ds_read_b64_tr_b16 v[52:53], v212 offset:256
    ds_read_b64_tr_b16 v[54:55], v212 offset:4352
    v_add_f32 v7, v24, v25
    ds_write_b32 v208, v7
    s_mov_b64 exec, s[98:99]
    ds_write_b32 v209, v200 offset:0
    ds_write_b32 v209, v201 offset:32
    ds_write_b32 v209, v202 offset:64
    ds_write_b32 v209, v203 offset:96
    s_mov_b64 exec, -1
    ds_write_b128 v210, v[144:147] offset:0
    ds_write_b128 v210, v[148:151] offset:1024
    ds_write_b128 v210, v[152:155] offset:2048
    ds_write_b128 v210, v[156:159] offset:3072
    s_waitcnt lgkmcnt(9)
    ds_write_b128 v213, v[48:51]
    ds_write_b128 v214, v[52:55] offset:128
    s_waitcnt lgkmcnt(0)
    s_barrier
    ds_read_b128 v[192:195], v215
    ds_read_b128 v[196:199], v215 offset:16
    ds_read_b128 v[48:51], v222 offset:0
    ds_read_b128 v[52:55], v222 offset:1024
    ds_read_b128 v[144:147], v211 offset:0
    ds_read_b128 v[148:151], v211 offset:1024
    ds_read_b128 v[152:155], v211 offset:2048
    ds_read_b128 v[156:159], v211 offset:3072
    s_waitcnt lgkmcnt(6)
    v_add_f32 v192, v192, v193
    v_add_f32 v194, v194, v195
    v_add_f32 v193, v192, v194
    v_add_f32 v192, v196, v197
    v_mul_f32 v192, 0x3b000000, v192
    v_mul_f32 v193, 0x3b000000, v193
    v_fma_f32 v193, -v192, v192, v193
    v_max_f32 v193, 0, v193
    v_add_f32 v193, 0x3727c5ac, v193
    v_rsq_f32 v193, v193
    s_nop 0
    ds_write_b32 v216, v193
    s_waitcnt lgkmcnt(5)
    buffer_store_dwordx4 v[48:51], v224, s[24:27], s47 offen sc1
    buffer_store_dwordx4 v[52:55], v224, s[24:27], s43 offen sc1
    s_waitcnt lgkmcnt(0)
    ds_read_b128 v[176:179], v217 offset:0
    ds_read_b128 v[180:183], v217 offset:32
    ds_read_b128 v[184:187], v217 offset:64
    ds_read_b128 v[188:191], v217 offset:96
    v_pk_add_f32 v[128:129], v[128:129], v[144:145]
    v_pk_add_f32 v[130:131], v[130:131], v[146:147]
    v_pk_add_f32 v[132:133], v[132:133], v[148:149]
    v_pk_add_f32 v[134:135], v[134:135], v[150:151]
    v_pk_add_f32 v[136:137], v[136:137], v[152:153]
    v_pk_add_f32 v[138:139], v[138:139], v[154:155]
    v_pk_add_f32 v[140:141], v[140:141], v[156:157]
    v_pk_add_f32 v[142:143], v[142:143], v[158:159]
    s_or_b32 s4, s33, s34
    s_cmp_lg_u32 s4, 0
    s_cbranch_scc1 SKIPMEAN_4
    s_mov_b32 exec_hi, 0
    buffer_store_dword v192, v218, s[28:31], 0 offen sc1
    s_mov_b64 exec, -1
SKIPMEAN_4:
    s_waitcnt lgkmcnt(0)
    v_pk_mul_f32 v[128:129], v[128:129], v[176:177]
    v_pk_mul_f32 v[130:131], v[130:131], v[178:179]
    v_pk_mul_f32 v[132:133], v[132:133], v[180:181]
    v_pk_mul_f32 v[134:135], v[134:135], v[182:183]
    v_pk_mul_f32 v[136:137], v[136:137], v[184:185]
    v_pk_mul_f32 v[138:139], v[138:139], v[186:187]
    v_pk_mul_f32 v[140:141], v[140:141], v[188:189]
    v_pk_mul_f32 v[142:143], v[142:143], v[190:191]
    v_cvt_pk_bf16_f32 v192, v128, v129
    v_cvt_pk_bf16_f32 v193, v130, v131
    v_cvt_pk_bf16_f32 v194, v132, v133
    v_cvt_pk_bf16_f32 v195, v134, v135
    v_cvt_pk_bf16_f32 v196, v136, v137
    v_cvt_pk_bf16_f32 v197, v138, v139
    v_cvt_pk_bf16_f32 v198, v140, v141
    v_cvt_pk_bf16_f32 v199, v142, v143
    ds_write_b128 v219, v[192:195]
    ds_write_b128 v220, v[196:199]
    s_waitcnt lgkmcnt(0)
    s_barrier
    ds_read_b128 v[192:195], v221 offset:0
    ds_read_b128 v[196:199], v221 offset:1024
    s_waitcnt lgkmcnt(0)
    buffer_store_dwordx4 v[192:195], v223, s[20:23], s45 offen sc1
    buffer_store_dwordx4 v[196:199], v223, s[20:23], s46 offen sc1
    s_add_u32 s44, s33, 0
    v_and_b32 v2, 15, v1
    v_lshrrev_b32 v3, 4, v1
    s_lshl_b32 s6, s3, 4
    v_add_u32 v7, s6, v2
    v_cvt_f32_u32 v8, v7
    v_mul_f32 v9, 0x3c800000, v8
    v_lshlrev_b32 v10, 3, v3
    v_cvt_f32_u32 v10, v10
    v_mul_f32 v11, v9, v10
    v_mov_b32 v12, 0
    v_fma_f32 v12, v9, v12, v11
    v_add_f32 v13, v12, v9
    v_cos_f32 v160, v12
    v_cos_f32 v161, v13
    v_sin_f32 v162, v12
    v_sin_f32 v163, v13
    v_cvt_pk_bf16_f32 v56, v160, v161
    v_cvt_pk_bf16_f32 v64, v162, v163
    v_xor_b32 v72, 0x80008000, v64
    v_mov_b32 v12, 0x40000000
    v_fma_f32 v12, v9, v12, v11
    v_add_f32 v13, v12, v9
    v_cos_f32 v160, v12
    v_cos_f32 v161, v13
    v_sin_f32 v162, v12
    v_sin_f32 v163, v13
    v_cvt_pk_bf16_f32 v57, v160, v161
    v_cvt_pk_bf16_f32 v65, v162, v163
    v_xor_b32 v73, 0x80008000, v65
    v_mov_b32 v12, 0x40800000
    v_fma_f32 v12, v9, v12, v11
    v_add_f32 v13, v12, v9
    v_cos_f32 v160, v12
    v_cos_f32 v161, v13
    v_sin_f32 v162, v12
    v_sin_f32 v163, v13
    v_cvt_pk_bf16_f32 v58, v160, v161
    v_cvt_pk_bf16_f32 v66, v162, v163
    v_xor_b32 v74, 0x80008000, v66
    v_mov_b32 v12, 0x40c00000
    v_fma_f32 v12, v9, v12, v11
    v_add_f32 v13, v12, v9
    v_cos_f32 v160, v12
    v_cos_f32 v161, v13
    v_sin_f32 v162, v12
    v_sin_f32 v163, v13
    v_cvt_pk_bf16_f32 v59, v160, v161
    v_cvt_pk_bf16_f32 v67, v162, v163
    v_xor_b32 v75, 0x80008000, v67
    v_mov_b32 v12, 0x42000000
    v_fma_f32 v12, v9, v12, v11
    v_add_f32 v13, v12, v9
    v_cos_f32 v160, v12
    v_cos_f32 v161, v13
    v_sin_f32 v162, v12
    v_sin_f32 v163, v13
    v_cvt_pk_bf16_f32 v60, v160, v161
    v_cvt_pk_bf16_f32 v68, v162, v163
    v_xor_b32 v76, 0x80008000, v68
    v_mov_b32 v12, 0x42080000
    v_fma_f32 v12, v9, v12, v11
    v_add_f32 v13, v12, v9
    v_cos_f32 v160, v12
    v_cos_f32 v161, v13
    v_sin_f32 v162, v12
    v_sin_f32 v163, v13
    v_cvt_pk_bf16_f32 v61, v160, v161
    v_cvt_pk_bf16_f32 v69, v162, v163
    v_xor_b32 v77, 0x80008000, v69
    v_mov_b32 v12, 0x42100000
    v_fma_f32 v12, v9, v12, v11
    v_add_f32 v13, v12, v9
    v_cos_f32 v160, v12
    v_cos_f32 v161, v13
    v_sin_f32 v162, v12
    v_sin_f32 v163, v13
    v_cvt_pk_bf16_f32 v62, v160, v161
    v_cvt_pk_bf16_f32 v70, v162, v163
    v_xor_b32 v78, 0x80008000, v70
    v_mov_b32 v12, 0x42180000
    v_fma_f32 v12, v9, v12, v11
    v_add_f32 v13, v12, v9
    v_cos_f32 v160, v12
    v_cos_f32 v161, v13
    v_sin_f32 v162, v12
    v_sin_f32 v163, v13
    v_cvt_pk_bf16_f32 v63, v160, v161
    v_cvt_pk_bf16_f32 v71, v162, v163
    v_xor_b32 v79, 0x80008000, v71
    v_lshlrev_b32 v10, 2, v3
    v_cvt_f32_u32 v10, v10
    v_add_u32 v7, 0, v2
    v_cvt_f32_u32 v9, v7
    v_mul_f32 v9, 0x3d000000, v9
    v_mul_f32 v11, v9, v10
    v_mov_b32 v12, 0
    v_fma_f32 v12, v9, v12, v11
    v_add_f32 v13, v12, v9
    v_cos_f32 v160, v12
    v_cos_f32 v161, v13
    v_sin_f32 v162, v12
    v_sin_f32 v163, v13
    v_cvt_pk_bf16_f32 v80, v160, v161
    v_cvt_pk_bf16_f32 v88, v162, v163
    v_xor_b32 v96, 0x80008000, v88
    v_mov_b32 v12, 0x40000000
    v_fma_f32 v12, v9, v12, v11
    v_add_f32 v13, v12, v9
    v_cos_f32 v160, v12
    v_cos_f32 v161, v13
    v_sin_f32 v162, v12
    v_sin_f32 v163, v13
    v_cvt_pk_bf16_f32 v81, v160, v161
    v_cvt_pk_bf16_f32 v89, v162, v163
    v_xor_b32 v97, 0x80008000, v89
    v_mov_b32 v12, 0x41800000
    v_fma_f32 v12, v9, v12, v11
    v_add_f32 v13, v12, v9
    v_cos_f32 v160, v12
    v_cos_f32 v161, v13
    v_sin_f32 v162, v12
    v_sin_f32 v163, v13
    v_cvt_pk_bf16_f32 v82, v160, v161
    v_cvt_pk_bf16_f32 v90, v162, v163
    v_xor_b32 v98, 0x80008000, v90
    v_mov_b32 v12, 0x41900000
    v_fma_f32 v12, v9, v12, v11
    v_add_f32 v13, v12, v9
    v_cos_f32 v160, v12
    v_cos_f32 v161, v13
    v_sin_f32 v162, v12
    v_sin_f32 v163, v13
    v_cvt_pk_bf16_f32 v83, v160, v161
    v_cvt_pk_bf16_f32 v91, v162, v163
    v_xor_b32 v99, 0x80008000, v91
    v_add_u32 v7, 16, v2
    v_cvt_f32_u32 v9, v7
    v_mul_f32 v9, 0x3d000000, v9
    v_mul_f32 v11, v9, v10
    v_mov_b32 v12, 0
    v_fma_f32 v12, v9, v12, v11
    v_add_f32 v13, v12, v9
    v_cos_f32 v160, v12
    v_cos_f32 v161, v13
    v_sin_f32 v162, v12
    v_sin_f32 v163, v13
    v_cvt_pk_bf16_f32 v84, v160, v161
    v_cvt_pk_bf16_f32 v92, v162, v163
    v_xor_b32 v100, 0x80008000, v92
    v_mov_b32 v12, 0x40000000
    v_fma_f32 v12, v9, v12, v11
    v_add_f32 v13, v12, v9
    v_cos_f32 v160, v12
    v_cos_f32 v161, v13
    v_sin_f32 v162, v12
    v_sin_f32 v163, v13
    v_cvt_pk_bf16_f32 v85, v160, v161
    v_cvt_pk_bf16_f32 v93, v162, v163
    v_xor_b32 v101, 0x80008000, v93
    v_mov_b32 v12, 0x41800000
    v_fma_f32 v12, v9, v12, v11
    v_add_f32 v13, v12, v9
    v_cos_f32 v160, v12
    v_cos_f32 v161, v13
    v_sin_f32 v162, v12
    v_sin_f32 v163, v13
    v_cvt_pk_bf16_f32 v86, v160, v161
    v_cvt_pk_bf16_f32 v94, v162, v163
    v_xor_b32 v102, 0x80008000, v94
    v_mov_b32 v12, 0x41900000
    v_fma_f32 v12, v9, v12, v11
    v_add_f32 v13, v12, v9
    v_cos_f32 v160, v12
    v_cos_f32 v161, v13
    v_sin_f32 v162, v12
    v_sin_f32 v163, v13
    v_cvt_pk_bf16_f32 v87, v160, v161
    v_cvt_pk_bf16_f32 v95, v162, v163
    v_xor_b32 v103, 0x80008000, v95
    v_mov_b32 v182, v8
    v_mov_b32 v183, v10
    s_waitcnt vmcnt(0)
    s_mov_b32 s60, 0x61a80
RDYP_6:
    v_readfirstlane_b32 s4, v30
    s_sub_u32 s60, s60, 1
    s_cmp_eq_u32 s60, 0
    s_cbranch_scc1 RDY_5
    s_nop 0
    s_cmp_eq_u32 s4, 1
    s_cbranch_scc1 RDY_5
    v_mov_b32 v10, 0
    buffer_load_dword v30, v10, s[92:95], 0 offen sc1
    s_waitcnt vmcnt(0)
    s_branch RDYP_6
RDY_5:
    s_waitcnt vmcnt(0)
    s_barrier
    s_cmp_lg_u32 s3, 0
    s_cbranch_scc1 ARR_7
    s_lshl_b32 s60, s44, 8
    v_mov_b32 v253, 0
    v_mov_b32 v254, 1
    s_mov_b64 exec, 1
    buffer_atomic_add v254, v253, s[84:87], s60 offen sc1
    s_mov_b64 exec, -1
ARR_7:
    v_mov_b32 v8, v182
    v_mov_b32 v10, v183
    s_mul_i32 s6, s2, 0x1c00
    v_subrev_u32 v4, 64, v0
    v_cmp_gt_u32 vcc, 0x70, v4
    v_lshlrev_b32 v4, 6, v4
    v_mov_b32 v5, 0x7ff00000
    v_cndmask_b32 v4, v5, v4, vcc
    s_mov_b32 s24, s72
    s_mov_b32 s25, s73
    s_mov_b32 s26, 0x1c0000
    s_mov_b32 s27, 0x20000
    buffer_load_dword v208, v4, s[24:27], s6 offen
    v_lshrrev_b32 v4, 3, v1
    v_and_b32 v5, 7, v1
    v_xor_b32 v5, v5, v4
    v_lshlrev_b32 v5, 4, v5
    v_lshl_add_u32 v179, v4, 7, v5
    v_and_b32 v4, 7, v2
    v_xor_b32 v4, v4, v3
    v_lshlrev_b32 v4, 4, v4
    v_lshl_add_u32 v181, v2, 7, v4
    v_add_u32 v181, 0x4000, v181
    v_lshlrev_b32 v180, 4, v0
    s_and_b32 s35, s2, 7
    s_lshl_b32 s35, s35, 5
    s_lshr_b32 s4, s2, 3
    s_add_u32 s35, s35, s4
    s_lshl_b32 s33, s35, 13
    s_add_u32 s34, s33, 0x1000
    s_mov_b32 s8, s82
    s_mov_b32 s9, s83
    s_mov_b32 s10, 0x200000
    s_mov_b32 s11, 0x20000
    s_add_u32 s12, s82, 0x200000
    s_addc_u32 s13, s83, 0
    s_mov_b32 s14, 0x200000
    s_mov_b32 s15, 0x20000
    s_add_u32 s16, s82, 0x400000
    s_addc_u32 s17, s83, 0
    s_mov_b32 s18, 0x200000
    s_mov_b32 s19, 0x20000
    s_cmp_eq_u32 s35, 0xff
    s_mov_b32 s32, 0x36000000
    s_cselect_b32 s32, 0x35800000, s32
    v_mul_f32 v9, 0x3a000000, v8
    v_mul_f32 v11, v9, v10
    v_mov_b32 v12, 0
    v_fma_f32 v12, v9, v12, v11
    v_cos_f32 v160, v12
    v_sin_f32 v161, v12
    s_nop 0
    v_mul_f32 v104, s32, v160
    v_mul_f32 v112, s32, v161
    v_mov_b32 v12, 0x3f800000
    v_fma_f32 v12, v9, v12, v11
    v_cos_f32 v160, v12
    v_sin_f32 v161, v12
    s_nop 0
    v_mul_f32 v105, s32, v160
    v_mul_f32 v113, s32, v161
    v_mov_b32 v12, 0x40000000
    v_fma_f32 v12, v9, v12, v11
    v_cos_f32 v160, v12
    v_sin_f32 v161, v12
    s_nop 0
    v_mul_f32 v106, s32, v160
    v_mul_f32 v114, s32, v161
    v_mov_b32 v12, 0x40400000
    v_fma_f32 v12, v9, v12, v11
    v_cos_f32 v160, v12
    v_sin_f32 v161, v12
    s_nop 0
    v_mul_f32 v107, s32, v160
    v_mul_f32 v115, s32, v161
    v_mov_b32 v12, 0x41800000
    v_fma_f32 v12, v9, v12, v11
    v_cos_f32 v160, v12
    v_sin_f32 v161, v12
    s_nop 0
    v_mul_f32 v108, s32, v160
    v_mul_f32 v116, s32, v161
    v_mov_b32 v12, 0x41880000
    v_fma_f32 v12, v9, v12, v11
    v_cos_f32 v160, v12
    v_sin_f32 v161, v12
    s_nop 0
    v_mul_f32 v109, s32, v160
    v_mul_f32 v117, s32, v161
    v_mov_b32 v12, 0x41900000
    v_fma_f32 v12, v9, v12, v11
    v_cos_f32 v160, v12
    v_sin_f32 v161, v12
    s_nop 0
    v_mul_f32 v110, s32, v160
    v_mul_f32 v118, s32, v161
    v_mov_b32 v12, 0x41980000
    v_fma_f32 v12, v9, v12, v11
    v_cos_f32 v160, v12
    v_sin_f32 v161, v12
    s_nop 0
    v_mul_f32 v111, s32, v160
    v_mul_f32 v119, s32, v161
    s_lshr_b32 s42, s35, 5
    s_add_u32 s42, s42, 0
    s_lshl_b32 s61, s42, 8
    s_cmp_eq_u32 s3, 0
    s_cselect_b32 s60, 0, 0x7ff00000
    v_lshlrev_b32 v250, 8, v1
    v_add_u32 v250, s60, v250
    s_lshl_b32 s6, s3, 4
    v_lshlrev_b32 v7, 2, v3
    v_add_u32 v7, s6, v7
    v_cvt_f32_u32 v7, v7
    v_add_u32 v9, 0, v2
    v_cvt_f32_u32 v9, v9
    v_mul_f32 v9, 0x3a000000, v9
    v_mul_f32 v11, v9, v7
    v_mov_b32 v12, v11
    v_cos_f32 v120, v12
    v_sin_f32 v128, v12
    v_add_f32 v12, v12, v9
    v_cos_f32 v121, v12
    v_sin_f32 v129, v12
    v_add_f32 v12, v12, v9
    v_cos_f32 v122, v12
    v_sin_f32 v130, v12
    v_add_f32 v12, v12, v9
    v_cos_f32 v123, v12
    v_sin_f32 v131, v12
    v_add_u32 v9, 16, v2
    v_cvt_f32_u32 v9, v9
    v_mul_f32 v9, 0x3a000000, v9
    v_mul_f32 v11, v9, v7
    v_mov_b32 v12, v11
    v_cos_f32 v124, v12
    v_sin_f32 v132, v12
    v_add_f32 v12, v12, v9
    v_cos_f32 v125, v12
    v_sin_f32 v133, v12
    v_add_f32 v12, v12, v9
    v_cos_f32 v126, v12
    v_sin_f32 v134, v12
    v_add_f32 v12, v12, v9
    v_cos_f32 v127, v12
    v_sin_f32 v135, v12
    s_movk_i32 s7, 0x90
    v_mul_lo_u32 v176, v2, s7
    s_lshl_b32 s6, s3, 5
    v_lshl_add_u32 v176, v3, 3, v176
    v_add_u32 v176, s6, v176
    v_lshrrev_b32 v12, 2, v2
    v_lshlrev_b32 v12, 3, v12
    v_and_b32 v13, 3, v2
    v_add_u32 v12, v12, v13
    v_mul_lo_u32 v177, v12, s7
    v_lshl_add_u32 v177, v3, 4, v177
    v_lshlrev_b32 v178, 6, v2
    v_lshl_add_u32 v178, v3, 4, v178
    s_lshl_b32 s6, s3, 10
    v_add_u32 v178, s6, v178
    s_and_b32 s4, s2, 3
    s_lshl_b32 s4, s4, 2
    s_lshr_b32 s5, s2, 3
    s_and_b32 s5, s5, 3
    s_add_u32 s54, s4, s5
    s_lshr_b32 s4, s2, 2
    s_and_b32 s4, s4, 1
    s_lshl_b32 s4, s4, 3
    s_lshr_b32 s5, s2, 5
    s_add_u32 s55, s4, s5
    s_and_b32 s4, s2, 7
    s_lshl_b32 s4, s4, 2
    s_lshr_b32 s5, s2, 3
    s_and_b32 s5, s5, 3
    s_add_u32 s56, s4, s5
    s_lshr_b32 s57, s2, 5
    s_mov_b32 s7, 0x12492493
    s_movk_i32 s6, 14
    v_add_u32 v184, 0, v1
    v_mul_hi_u32 v185, v184, s7
    v_mul_lo_u32 v186, v185, s6
    v_sub_u32 v186, v184, v186
    v_mul_u32_u24 v185, 0xe00, v185
    v_lshl_add_u32 v240, v186, 4, v185
    v_add_u32 v184, 64, v1
    v_mul_hi_u32 v185, v184, s7
    v_mul_lo_u32 v186, v185, s6
    v_sub_u32 v186, v184, v186
    v_mul_u32_u24 v185, 0xe00, v185
    v_lshl_add_u32 v241, v186, 4, v185
    v_subrev_u32 v241, 0x400, v241
    v_add_u32 v184, 0x80, v1
    v_mul_hi_u32 v185, v184, s7
    v_mul_lo_u32 v186, v185, s6
    v_sub_u32 v186, v184, v186
    v_mul_u32_u24 v185, 0xe00, v185
    v_lshl_add_u32 v242, v186, 4, v185
    v_subrev_u32 v242, 0x800, v242
    v_add_u32 v184, 0xc0, v1
    v_mul_hi_u32 v185, v184, s7
    v_mul_lo_u32 v186, v185, s6
    v_sub_u32 v186, v184, v186
    v_mul_u32_u24 v185, 0xe00, v185
    v_lshl_add_u32 v243, v186, 4, v185
    v_subrev_u32 v243, 0xc00, v243
    v_add_u32 v184, 0x100, v1
    v_mul_hi_u32 v185, v184, s7
    v_mul_lo_u32 v186, v185, s6
    v_sub_u32 v186, v184, v186
    v_mul_u32_u24 v185, 0xe00, v185
    v_lshl_add_u32 v244, v186, 4, v185
    v_add_u32 v184, 0x140, v1
    v_mul_hi_u32 v185, v184, s7
    v_mul_lo_u32 v186, v185, s6
    v_sub_u32 v186, v184, v186
    v_mul_u32_u24 v185, 0xe00, v185
    v_lshl_add_u32 v245, v186, 4, v185
    v_subrev_u32 v245, 0x400, v245
    v_add_u32 v184, 0x180, v1
    v_mul_hi_u32 v185, v184, s7
    v_mul_lo_u32 v186, v185, s6
    v_sub_u32 v186, v184, v186
    v_mul_u32_u24 v185, 0xe00, v185
    v_lshl_add_u32 v246, v186, 4, v185
    v_subrev_u32 v246, 0x800, v246
    s_cmp_lt_u32 s3, 2
    s_cselect_b32 s48, s72, s74
    s_cselect_b32 s49, s73, s75
    s_mov_b32 s50, 0x1c0000
    s_mov_b32 s51, 0x20000
    s_and_b32 s4, s3, 1
    s_mul_i32 s53, s4, 0x1c000
    s_mul_i32 s5, s55, 0xe0
    s_add_u32 s53, s53, s5
    s_mul_i32 s52, s4, 0x1c00
    s_lshr_b32 s5, s3, 1
    s_mul_i32 s5, s5, 0x3880
    s_add_u32 s52, s52, s5
    s_cmp_lg_u32 s3, 0
    s_cbranch_scc1 WSK_8
    s_mov_b32 s60, 0x61a80
    s_mov_b64 exec, 1
POLL_9:
    buffer_load_dword v251, v250, s[84:87], s61 offen sc1
    s_waitcnt vmcnt(0)
    v_cmp_ne_u32 vcc, 32, v251
    s_sub_u32 s60, s60, 1
    s_cmp_eq_u32 s60, 0
    s_cbranch_scc1 PDN_10
    s_nop 1
    s_cbranch_vccz PDN_10
    s_sleep 1
    s_branch POLL_9
PDN_10:
    s_mov_b64 exec, -1
WSK_8:
    s_barrier
    s_sub_u32 s4, s3, 1
    s_cmp_lt_u32 s4, 2
    s_cbranch_scc1 NOIN_11
    s_lshr_b32 s4, s3, 1
    s_lshl_b32 s4, s4, 12
    s_add_u32 s5, s33, s4
    s_add_u32 m0, s4, 0x4000
    s_nop 0
    buffer_load_dwordx4 v179, s[8:11], s5 offen sc1 lds
    buffer_load_dwordx4 v179, s[8:11], s5 offen offset:1024 sc1 lds
    buffer_load_dwordx4 v179, s[8:11], s5 offen offset:2048 sc1 lds
    buffer_load_dwordx4 v179, s[8:11], s5 offen offset:3072 sc1 lds
NOIN_11:
    buffer_load_dwordx4 v[48:51], v180, s[12:15], s33 offen sc1
    buffer_load_dwordx4 v[52:55], v180, s[12:15], s34 offen sc1
    s_mul_i32 s6, s2, 0x1c00
    v_subrev_u32 v4, 64, v0
    v_cmp_gt_u32 vcc, 0x70, v4
    v_lshlrev_b32 v4, 6, v4
    v_mov_b32 v5, 0x7ff00000
    v_cndmask_b32 v4, v5, v4, vcc
    s_mov_b32 s24, s74
    s_mov_b32 s25, s75
    s_mov_b32 s26, 0x1c0000
    s_mov_b32 s27, 0x20000
    buffer_load_dword v209, v4, s[24:27], s6 offen
    s_sub_u32 s4, s3, 1
    s_cmp_lt_u32 s4, 2
    s_cbranch_scc1 NOINW_12
    s_waitcnt vmcnt(3)
NOINW_12:
    s_barrier
    v_xor_b32 v4, 64, v181
    ds_read_b128 v[16:19], v181 offset:0
    ds_read_b128 v[20:23], v4 offset:0
    ds_read_b128 v[32:35], v181 offset:4096
    ds_read_b128 v[36:39], v4 offset:4096
    ds_read_b128 v[24:27], v181 offset:2048
    ds_read_b128 v[28:31], v4 offset:2048
    ds_read_b128 v[40:43], v181 offset:6144
    ds_read_b128 v[44:47], v4 offset:6144
    s_waitcnt lgkmcnt(4)
    v_mfma_f32_16x16x32_bf16 v[136:139], v[16:19], v[56:59], 0
    v_mfma_f32_16x16x32_bf16 v[144:147], v[32:35], v[56:59], 0
    v_mfma_f32_16x16x32_bf16 v[136:139], v[32:35], v[64:67], v[136:139]
    v_mfma_f32_16x16x32_bf16 v[144:147], v[16:19], v[72:75], v[144:147]
    v_mfma_f32_16x16x32_bf16 v[136:139], v[20:23], v[60:63], v[136:139]
    v_mfma_f32_16x16x32_bf16 v[144:147], v[36:39], v[60:63], v[144:147]
    v_mfma_f32_16x16x32_bf16 v[136:139], v[36:39], v[68:71], v[136:139]
    v_mfma_f32_16x16x32_bf16 v[144:147], v[20:23], v[76:79], v[144:147]
    s_waitcnt lgkmcnt(0)
    v_mfma_f32_16x16x32_bf16 v[140:143], v[24:27], v[56:59], 0
    v_mfma_f32_16x16x32_bf16 v[148:151], v[40:43], v[56:59], 0
    v_mfma_f32_16x16x32_bf16 v[140:143], v[40:43], v[64:67], v[140:143]
    v_mfma_f32_16x16x32_bf16 v[148:151], v[24:27], v[72:75], v[148:151]
    v_mfma_f32_16x16x32_bf16 v[140:143], v[28:31], v[60:63], v[140:143]
    v_mfma_f32_16x16x32_bf16 v[148:151], v[44:47], v[60:63], v[148:151]
    v_mfma_f32_16x16x32_bf16 v[140:143], v[44:47], v[68:71], v[140:143]
    v_mfma_f32_16x16x32_bf16 v[148:151], v[28:31], v[76:79], v[148:151]
    v_pk_mul_f32 v[168:169], v[144:145], v[112:113]
    v_pk_mul_f32 v[170:171], v[136:137], v[112:113]
    v_pk_fma_f32 v[160:161], v[136:137], v[104:105], v[168:169]
    v_pk_fma_f32 v[164:165], v[144:145], v[104:105], v[170:171] neg_lo:[0,0,1] neg_hi:[0,0,1]
    v_pk_mul_f32 v[172:173], v[146:147], v[114:115]
    v_pk_mul_f32 v[174:175], v[138:139], v[114:115]
    v_pk_fma_f32 v[162:163], v[138:139], v[106:107], v[172:173]
    v_pk_fma_f32 v[166:167], v[146:147], v[106:107], v[174:175] neg_lo:[0,0,1] neg_hi:[0,0,1]
    v_cvt_pk_bf16_f32 v152, v160, v161
    v_cvt_pk_bf16_f32 v153, v162, v163
    v_cvt_pk_bf16_f32 v156, v164, v165
    v_cvt_pk_bf16_f32 v157, v166, v167
    v_pk_mul_f32 v[168:169], v[148:149], v[116:117]
    v_pk_mul_f32 v[170:171], v[140:141], v[116:117]
    v_pk_fma_f32 v[160:161], v[140:141], v[108:109], v[168:169]
    v_pk_fma_f32 v[164:165], v[148:149], v[108:109], v[170:171] neg_lo:[0,0,1] neg_hi:[0,0,1]
    v_pk_mul_f32 v[172:173], v[150:151], v[118:119]
    v_pk_mul_f32 v[174:175], v[142:143], v[118:119]
    v_pk_fma_f32 v[162:163], v[142:143], v[110:111], v[172:173]
    v_pk_fma_f32 v[166:167], v[150:151], v[110:111], v[174:175] neg_lo:[0,0,1] neg_hi:[0,0,1]
    v_cvt_pk_bf16_f32 v154, v160, v161
    v_cvt_pk_bf16_f32 v155, v162, v163
    v_cvt_pk_bf16_f32 v158, v164, v165
    v_cvt_pk_bf16_f32 v159, v166, v167
    v_mfma_f32_16x16x32_bf16 v[136:139], v[80:83], v[152:155], 0
    s_nop 0
    v_mfma_f32_16x16x32_bf16 v[144:147], v[80:83], v[156:159], 0
    v_mfma_f32_16x16x32_bf16 v[136:139], v[88:91], v[156:159], v[136:139]
    v_mfma_f32_16x16x32_bf16 v[144:147], v[96:99], v[152:155], v[144:147]
    v_mfma_f32_16x16x32_bf16 v[140:143], v[84:87], v[152:155], 0
    v_mfma_f32_16x16x32_bf16 v[148:151], v[84:87], v[156:159], 0
    v_mfma_f32_16x16x32_bf16 v[140:143], v[92:95], v[156:159], v[140:143]
    v_mfma_f32_16x16x32_bf16 v[148:151], v[100:103], v[152:155], v[148:151]
    s_waitcnt vmcnt(1)
    v_lshlrev_b32 v184, 16, v48
    v_and_b32 v185, 0xffff0000, v48
    v_lshlrev_b32 v186, 16, v49
    v_and_b32 v187, 0xffff0000, v49
    v_lshlrev_b32 v188, 16, v50
    v_and_b32 v189, 0xffff0000, v50
    v_lshlrev_b32 v190, 16, v51
    v_and_b32 v191, 0xffff0000, v51
    v_lshlrev_b32 v192, 16, v52
    v_and_b32 v193, 0xffff0000, v52
    v_lshlrev_b32 v194, 16, v53
    v_and_b32 v195, 0xffff0000, v53
    v_lshlrev_b32 v196, 16, v54
    v_and_b32 v197, 0xffff0000, v54
    v_lshlrev_b32 v198, 16, v55
    v_and_b32 v199, 0xffff0000, v55
    v_pk_mul_f32 v[168:169], v[144:145], v[188:189]
    v_pk_mul_f32 v[170:171], v[136:137], v[188:189]
    v_pk_fma_f32 v[160:161], v[136:137], v[184:185], v[168:169] neg_lo:[0,0,1] neg_hi:[0,0,1]
    v_pk_fma_f32 v[164:165], v[144:145], v[184:185], v[170:171]
    v_pk_mul_f32 v[172:173], v[146:147], v[190:191]
    v_pk_mul_f32 v[174:175], v[138:139], v[190:191]
    v_pk_fma_f32 v[162:163], v[138:139], v[186:187], v[172:173] neg_lo:[0,0,1] neg_hi:[0,0,1]
    v_pk_fma_f32 v[166:167], v[146:147], v[186:187], v[174:175]
    v_cvt_pk_bf16_f32 v200, v160, v161
    v_cvt_pk_bf16_f32 v201, v162, v163
    v_cvt_pk_bf16_f32 v204, v164, v165
    v_cvt_pk_bf16_f32 v205, v166, v167
    v_pk_mul_f32 v[168:169], v[148:149], v[196:197]
    v_pk_mul_f32 v[170:171], v[140:141], v[196:197]
    v_pk_fma_f32 v[160:161], v[140:141], v[192:193], v[168:169] neg_lo:[0,0,1] neg_hi:[0,0,1]
    v_pk_fma_f32 v[164:165], v[148:149], v[192:193], v[170:171]
    v_pk_mul_f32 v[172:173], v[150:151], v[198:199]
    v_pk_mul_f32 v[174:175], v[142:143], v[198:199]
    v_pk_fma_f32 v[162:163], v[142:143], v[194:195], v[172:173] neg_lo:[0,0,1] neg_hi:[0,0,1]
    v_pk_fma_f32 v[166:167], v[150:151], v[194:195], v[174:175]
    v_cvt_pk_bf16_f32 v202, v160, v161
    v_cvt_pk_bf16_f32 v203, v162, v163
    v_cvt_pk_bf16_f32 v206, v164, v165
    v_cvt_pk_bf16_f32 v207, v166, v167
    v_mfma_f32_16x16x32_bf16 v[136:139], v[200:203], v[80:83], 0
    s_nop 0
    v_mfma_f32_16x16x32_bf16 v[144:147], v[204:207], v[80:83], 0
    v_mfma_f32_16x16x32_bf16 v[136:139], v[204:207], v[96:99], v[136:139]
    v_mfma_f32_16x16x32_bf16 v[144:147], v[200:203], v[88:91], v[144:147]
    v_mfma_f32_16x16x32_bf16 v[140:143], v[200:203], v[84:87], 0
    v_mfma_f32_16x16x32_bf16 v[148:151], v[204:207], v[84:87], 0
    v_mfma_f32_16x16x32_bf16 v[140:143], v[204:207], v[100:103], v[140:143]
    v_mfma_f32_16x16x32_bf16 v[148:151], v[200:203], v[92:95], v[148:151]
    s_nop 3
    v_pk_mul_f32 v[168:169], v[144:145], v[128:129]
    v_pk_mul_f32 v[170:171], v[136:137], v[128:129]
    v_pk_fma_f32 v[160:161], v[136:137], v[120:121], v[168:169] neg_lo:[0,0,1] neg_hi:[0,0,1]
    v_pk_fma_f32 v[164:165], v[144:145], v[120:121], v[170:171]
    v_pk_mul_f32 v[172:173], v[146:147], v[130:131]
    v_pk_mul_f32 v[174:175], v[138:139], v[130:131]
    v_pk_fma_f32 v[162:163], v[138:139], v[122:123], v[172:173] neg_lo:[0,0,1] neg_hi:[0,0,1]
    v_pk_fma_f32 v[166:167], v[146:147], v[122:123], v[174:175]
    v_cvt_pk_bf16_f32 v152, v160, v161
    v_cvt_pk_bf16_f32 v153, v162, v163
    v_cvt_pk_bf16_f32 v156, v164, v165
    v_cvt_pk_bf16_f32 v157, v166, v167
    ds_write_b64 v176, v[152:153] offset:0
    ds_write_b64 v176, v[156:157] offset:4608
    v_pk_mul_f32 v[168:169], v[148:149], v[132:133]
    v_pk_mul_f32 v[170:171], v[140:141], v[132:133]
    v_pk_fma_f32 v[160:161], v[140:141], v[124:125], v[168:169] neg_lo:[0,0,1] neg_hi:[0,0,1]
    v_pk_fma_f32 v[164:165], v[148:149], v[124:125], v[170:171]
    v_pk_mul_f32 v[172:173], v[150:151], v[134:135]
    v_pk_mul_f32 v[174:175], v[142:143], v[134:135]
    v_pk_fma_f32 v[162:163], v[142:143], v[126:127], v[172:173] neg_lo:[0,0,1] neg_hi:[0,0,1]
    v_pk_fma_f32 v[166:167], v[150:151], v[126:127], v[174:175]
    v_cvt_pk_bf16_f32 v154, v160, v161
    v_cvt_pk_bf16_f32 v155, v162, v163
    v_cvt_pk_bf16_f32 v158, v164, v165
    v_cvt_pk_bf16_f32 v159, v166, v167
    ds_write_b64 v176, v[154:155] offset:2304
    ds_write_b64 v176, v[158:159] offset:6912
    s_waitcnt lgkmcnt(0)
    s_barrier
    ds_read_b128 v[16:19], v177 offset:0
    ds_read_b128 v[20:23], v177 offset:64
    ds_read_b128 v[32:35], v177 offset:4608
    ds_read_b128 v[36:39], v177 offset:4672
    ds_read_b128 v[24:27], v177 offset:576
    ds_read_b128 v[28:31], v177 offset:640
    ds_read_b128 v[40:43], v177 offset:5184
    ds_read_b128 v[44:47], v177 offset:5248
    s_waitcnt lgkmcnt(4)
    v_mfma_f32_16x16x32_bf16 v[136:139], v[16:19], v[56:59], 0
    v_mfma_f32_16x16x32_bf16 v[144:147], v[32:35], v[56:59], 0
    v_mfma_f32_16x16x32_bf16 v[136:139], v[32:35], v[72:75], v[136:139]
    v_mfma_f32_16x16x32_bf16 v[144:147], v[16:19], v[64:67], v[144:147]
    v_mfma_f32_16x16x32_bf16 v[136:139], v[20:23], v[60:63], v[136:139]
    v_mfma_f32_16x16x32_bf16 v[144:147], v[36:39], v[60:63], v[144:147]
    v_mfma_f32_16x16x32_bf16 v[136:139], v[36:39], v[76:79], v[136:139]
    v_mfma_f32_16x16x32_bf16 v[144:147], v[20:23], v[68:71], v[144:147]
    s_waitcnt lgkmcnt(0)
    v_mfma_f32_16x16x32_bf16 v[140:143], v[24:27], v[56:59], 0
    v_mfma_f32_16x16x32_bf16 v[148:151], v[40:43], v[56:59], 0
    v_mfma_f32_16x16x32_bf16 v[140:143], v[40:43], v[72:75], v[140:143]
    v_mfma_f32_16x16x32_bf16 v[148:151], v[24:27], v[64:67], v[148:151]
    v_mfma_f32_16x16x32_bf16 v[140:143], v[28:31], v[60:63], v[140:143]
    v_mfma_f32_16x16x32_bf16 v[148:151], v[44:47], v[60:63], v[148:151]
    v_mfma_f32_16x16x32_bf16 v[140:143], v[44:47], v[76:79], v[140:143]
    v_mfma_f32_16x16x32_bf16 v[148:151], v[28:31], v[68:71], v[148:151]
    v_cvt_pk_bf16_f32 v152, v136, v137
    v_cvt_pk_bf16_f32 v153, v138, v139
    s_nop 4
    v_cvt_pk_bf16_f32 v154, v140, v141
    v_cvt_pk_bf16_f32 v155, v142, v143
    buffer_store_dwordx4 v[152:155], v178, s[16:19], s33 offen sc1
    v_cvt_pk_bf16_f32 v156, v144, v145
    v_cvt_pk_bf16_f32 v157, v146, v147
    v_cvt_pk_bf16_f32 v158, v148, v149
    v_cvt_pk_bf16_f32 v159, v150, v151
    buffer_store_dwordx4 v[156:159], v178, s[16:19], s34 offen sc1
    s_lshr_b32 s42, s2, 3
    s_and_b32 s42, s42, 7
    s_add_u32 s42, s42, 48
    s_add_u32 s62, s53, 0
    s_add_u32 m0, s52, 0x10000
    s_nop 0
    buffer_load_dwordx4 v240, s[48:51], s62 offen lds
    s_add_u32 m0, s52, 0x10000
    s_nop 0
    buffer_load_dwordx4 v241, s[48:51], s62 offen offset:1024 lds
    s_add_u32 m0, s52, 0x10000
    s_nop 0
    buffer_load_dwordx4 v242, s[48:51], s62 offen offset:2048 lds
    s_add_u32 m0, s52, 0x10000
    s_nop 0
    buffer_load_dwordx4 v243, s[48:51], s62 offen offset:3072 lds
    s_add_u32 m0, s52, 0x11000
    s_nop 0
    buffer_load_dwordx4 v244, s[48:51], s62 offen lds
    s_add_u32 m0, s52, 0x11000
    s_nop 0
    buffer_load_dwordx4 v245, s[48:51], s62 offen offset:1024 lds
    s_add_u32 m0, s52, 0x11000
    s_nop 0
    buffer_load_dwordx4 v246, s[48:51], s62 offen offset:2048 lds
    s_waitcnt vmcnt(7)
    s_barrier
    s_cmp_lg_u32 s3, 0
    s_cbranch_scc1 ARR_13
    s_lshl_b32 s60, s42, 8
    v_mul_u32_u24 v253, 0x800, v1
    v_mov_b32 v254, 1
    s_mov_b64 exec, 0xff
    buffer_atomic_add v254, v253, s[84:87], s60 offen sc1
    s_mov_b64 exec, -1
ARR_13:
    v_and_b32 v2, 31, v1
    v_lshrrev_b32 v3, 5, v1
    v_lshlrev_b32 v16, 4, v1
    s_and_b32 s34, s3, 1
    s_lshr_b32 s35, s3, 1
    v_lshrrev_b32 v5, 3, v1
    v_bfe_u32 v6, v1, 4, 1
    v_lshlrev_b32 v6, 2, v6
    v_and_b32 v7, 7, v1
    v_xor_b32 v6, v6, v7
    v_lshlrev_b32 v6, 4, v6
    v_lshl_add_u32 v23, v5, 12, v6
    s_add_u32 s12, s82, 0x400000
    s_addc_u32 s13, s83, 0
    s_mov_b32 s14, 0x200000
    s_mov_b32 s15, 0x20000
    s_mov_b32 s8, s64
    s_mov_b32 s9, s65
    s_mov_b32 s10, 0x200000
    s_mov_b32 s11, 0x20000
    s_add_u32 s20, s82, 0xf00000
    s_addc_u32 s21, s83, 0
    s_mov_b32 s22, 0x2000
    s_mov_b32 s23, 0x20000
    s_add_u32 s16, s82, 0x600000
    s_addc_u32 s17, s83, 0
    s_mov_b32 s18, 0x200000
    s_mov_b32 s19, 0x20000
    s_add_u32 s24, s82, 0xf10000
    s_addc_u32 s25, s83, 0
    s_mov_b32 s26, 0x20000
    s_mov_b32 s27, 0x20000
    s_lshl_b32 s4, s56, 6
    s_lshl_b32 s5, s35, 5
    s_add_u32 s4, s4, s5
    v_add_u32 v32, s4, v2
    v_lshlrev_b32 v33, 10, v32
    v_lshl_add_u32 v33, v3, 5, v33
    s_lshl_b32 s4, s57, 7
    s_lshl_b32 s5, s34, 6
    s_add_u32 s4, s4, s5
    buffer_load_dwordx4 v[24:27], v33, s[8:11], s4 offen
    buffer_load_dwordx4 v[28:31], v33, s[8:11], s4 offen offset:16
    v_bfe_u32 v10, v2, 2, 1
    v_lshlrev_b32 v10, 4, v10
    v_lshrrev_b32 v11, 3, v2
    v_lshl_add_u32 v10, v11, 2, v10
    v_and_b32 v11, 3, v2
    v_add_u32 v10, v10, v11
    s_lshl_b32 s4, s57, 6
    s_lshl_b32 s5, s34, 5
    s_add_u32 s4, s4, s5
    v_add_u32 v10, s4, v10
    v_cvt_f32_u32 v17, v10
    v_mul_f32 v17, 0x3b000000, v17
    s_lshl_b32 s4, s35, 6
    s_add_u32 s4, s4, 1
    v_lshlrev_b32 v11, 2, v3
    v_add_u32 v11, s4, v11
    v_cvt_f32_u32 v11, v11
    v_mul_f32 v18, v17, v11
    v_mul_f32 v19, 0x40a00000, v17
    v_and_b32 v34, 1, v10
    v_lshlrev_b32 v34, 4, v34
    v_and_b32 v11, 3, v10
    v_mov_b32 v35, 0
    v_cmp_eq_u32 vcc, 1, v11
    v_mov_b32 v12, 0x80000000
    s_nop 0
    v_cndmask_b32 v35, v35, v12, vcc
    v_cmp_eq_u32 vcc, 2, v11
    v_mov_b32 v12, 0x80008000
    s_nop 0
    v_cndmask_b32 v35, v35, v12, vcc
    v_cmp_eq_u32 vcc, 3, v11
    v_mov_b32 v12, 0x8000
    s_nop 0
    v_cndmask_b32 v35, v35, v12, vcc
    s_and_b32 s42, s2, 7
    s_lshl_b32 s42, s42, 3
    s_add_u32 s42, s42, 48
    s_lshl_b32 s61, s42, 8
    s_cmp_eq_u32 s3, 0
    s_cselect_b32 s60, 0, 0x7ff00000
    v_lshlrev_b32 v250, 8, v1
    v_add_u32 v250, s60, v250
    v_cos_f32 v12, v18
    v_sin_f32_e64 v13, -v18
    v_add_f32 v18, v18, v17
    v_cvt_pk_bf16_f32 v64, v12, v13
    v_alignbit_b32 v96, v64, v64, v34
    v_xor_b32 v96, v35, v96
    s_add_u32 s62, s53, 0x38000
    s_add_u32 m0, s52, 0x17100
    s_nop 0
    buffer_load_dwordx4 v240, s[48:51], s62 offen lds
    v_cos_f32 v14, v18
    v_sin_f32_e64 v15, -v18
    v_add_f32 v18, v18, v17
    v_cvt_pk_bf16_f32 v65, v14, v15
    v_alignbit_b32 v97, v65, v65, v34
    v_xor_b32 v97, v35, v97
    s_add_u32 m0, s52, 0x17100
    s_nop 0
    buffer_load_dwordx4 v241, s[48:51], s62 offen offset:1024 lds
    v_cos_f32 v12, v18
    v_sin_f32_e64 v13, -v18
    v_add_f32 v18, v18, v17
    v_cvt_pk_bf16_f32 v66, v12, v13
    v_alignbit_b32 v98, v66, v66, v34
    v_xor_b32 v98, v35, v98
    s_add_u32 m0, s52, 0x17100
    s_nop 0
    buffer_load_dwordx4 v242, s[48:51], s62 offen offset:2048 lds
    v_cos_f32 v14, v18
    v_sin_f32_e64 v15, -v18
    v_add_f32 v18, v18, v19
    v_cvt_pk_bf16_f32 v67, v14, v15
    v_alignbit_b32 v99, v67, v67, v34
    v_xor_b32 v99, v35, v99
    s_add_u32 m0, s52, 0x17100
    s_nop 0
    buffer_load_dwordx4 v243, s[48:51], s62 offen offset:3072 lds
    v_cos_f32 v12, v18
    v_sin_f32_e64 v13, -v18
    v_add_f32 v18, v18, v17
    v_cvt_pk_bf16_f32 v68, v12, v13
    v_alignbit_b32 v100, v68, v68, v34
    v_xor_b32 v100, v35, v100
    s_add_u32 m0, s52, 0x18100
    s_nop 0
    buffer_load_dwordx4 v244, s[48:51], s62 offen lds
    v_cos_f32 v14, v18
    v_sin_f32_e64 v15, -v18
    v_add_f32 v18, v18, v17
    v_cvt_pk_bf16_f32 v69, v14, v15
    v_alignbit_b32 v101, v69, v69, v34
    v_xor_b32 v101, v35, v101
    s_add_u32 m0, s52, 0x18100
    s_nop 0
    buffer_load_dwordx4 v245, s[48:51], s62 offen offset:1024 lds
    v_cos_f32 v12, v18
    v_sin_f32_e64 v13, -v18
    v_add_f32 v18, v18, v17
    v_cvt_pk_bf16_f32 v70, v12, v13
    v_alignbit_b32 v102, v70, v70, v34
    v_xor_b32 v102, v35, v102
    s_add_u32 m0, s52, 0x18100
    s_nop 0
    buffer_load_dwordx4 v246, s[48:51], s62 offen offset:2048 lds
    v_cos_f32 v14, v18
    v_sin_f32_e64 v15, -v18
    v_add_f32 v18, v18, v19
    v_cvt_pk_bf16_f32 v71, v14, v15
    v_alignbit_b32 v103, v71, v71, v34
    v_xor_b32 v103, v35, v103
    v_cos_f32 v12, v18
    v_sin_f32_e64 v13, -v18
    v_add_f32 v18, v18, v17
    v_cvt_pk_bf16_f32 v72, v12, v13
    v_alignbit_b32 v104, v72, v72, v34
    v_xor_b32 v104, v35, v104
    v_cos_f32 v14, v18
    v_sin_f32_e64 v15, -v18
    v_add_f32 v18, v18, v17
    v_cvt_pk_bf16_f32 v73, v14, v15
    v_alignbit_b32 v105, v73, v73, v34
    v_xor_b32 v105, v35, v105
    v_cos_f32 v12, v18
    v_sin_f32_e64 v13, -v18
    v_add_f32 v18, v18, v17
    v_cvt_pk_bf16_f32 v74, v12, v13
    v_alignbit_b32 v106, v74, v74, v34
    v_xor_b32 v106, v35, v106
    v_cos_f32 v14, v18
    v_sin_f32_e64 v15, -v18
    v_add_f32 v18, v18, v19
    v_cvt_pk_bf16_f32 v75, v14, v15
    v_alignbit_b32 v107, v75, v75, v34
    v_xor_b32 v107, v35, v107
    v_cos_f32 v12, v18
    v_sin_f32_e64 v13, -v18
    v_add_f32 v18, v18, v17
    v_cvt_pk_bf16_f32 v76, v12, v13
    v_alignbit_b32 v108, v76, v76, v34
    v_xor_b32 v108, v35, v108
    v_cos_f32 v14, v18
    v_sin_f32_e64 v15, -v18
    v_add_f32 v18, v18, v17
    v_cvt_pk_bf16_f32 v77, v14, v15
    v_alignbit_b32 v109, v77, v77, v34
    v_xor_b32 v109, v35, v109
    v_cos_f32 v12, v18
    v_sin_f32_e64 v13, -v18
    v_add_f32 v18, v18, v17
    v_cvt_pk_bf16_f32 v78, v12, v13
    v_alignbit_b32 v110, v78, v78, v34
    v_xor_b32 v110, v35, v110
    v_cos_f32 v14, v18
    v_sin_f32_e64 v15, -v18
    v_add_f32 v18, v18, v19
    v_cvt_pk_bf16_f32 v79, v14, v15
    v_alignbit_b32 v111, v79, v79, v34
    v_xor_b32 v111, v35, v111
    v_cos_f32 v12, v18
    v_sin_f32_e64 v13, -v18
    v_add_f32 v18, v18, v17
    v_cvt_pk_bf16_f32 v80, v12, v13
    v_alignbit_b32 v112, v80, v80, v34
    v_xor_b32 v112, v35, v112
    v_cos_f32 v14, v18
    v_sin_f32_e64 v15, -v18
    v_add_f32 v18, v18, v17
    v_cvt_pk_bf16_f32 v81, v14, v15
    v_alignbit_b32 v113, v81, v81, v34
    v_xor_b32 v113, v35, v113
    v_cos_f32 v12, v18
    v_sin_f32_e64 v13, -v18
    v_add_f32 v18, v18, v17
    v_cvt_pk_bf16_f32 v82, v12, v13
    v_alignbit_b32 v114, v82, v82, v34
    v_xor_b32 v114, v35, v114
    v_cos_f32 v14, v18
    v_sin_f32_e64 v15, -v18
    v_add_f32 v18, v18, v19
    v_cvt_pk_bf16_f32 v83, v14, v15
    v_alignbit_b32 v115, v83, v83, v34
    v_xor_b32 v115, v35, v115
    v_cos_f32 v12, v18
    v_sin_f32_e64 v13, -v18
    v_add_f32 v18, v18, v17
    v_cvt_pk_bf16_f32 v84, v12, v13
    v_alignbit_b32 v116, v84, v84, v34
    v_xor_b32 v116, v35, v116
    v_cos_f32 v14, v18
    v_sin_f32_e64 v15, -v18
    v_add_f32 v18, v18, v17
    v_cvt_pk_bf16_f32 v85, v14, v15
    v_alignbit_b32 v117, v85, v85, v34
    v_xor_b32 v117, v35, v117
    v_cos_f32 v12, v18
    v_sin_f32_e64 v13, -v18
    v_add_f32 v18, v18, v17
    v_cvt_pk_bf16_f32 v86, v12, v13
    v_alignbit_b32 v118, v86, v86, v34
    v_xor_b32 v118, v35, v118
    v_cos_f32 v14, v18
    v_sin_f32_e64 v15, -v18
    v_add_f32 v18, v18, v19
    v_cvt_pk_bf16_f32 v87, v14, v15
    v_alignbit_b32 v119, v87, v87, v34
    v_xor_b32 v119, v35, v119
    v_cos_f32 v12, v18
    v_sin_f32_e64 v13, -v18
    v_add_f32 v18, v18, v17
    v_cvt_pk_bf16_f32 v88, v12, v13
    v_alignbit_b32 v120, v88, v88, v34
    v_xor_b32 v120, v35, v120
    v_cos_f32 v14, v18
    v_sin_f32_e64 v15, -v18
    v_add_f32 v18, v18, v17
    v_cvt_pk_bf16_f32 v89, v14, v15
    v_alignbit_b32 v121, v89, v89, v34
    v_xor_b32 v121, v35, v121
    v_cos_f32 v12, v18
    v_sin_f32_e64 v13, -v18
    v_add_f32 v18, v18, v17
    v_cvt_pk_bf16_f32 v90, v12, v13
    v_alignbit_b32 v122, v90, v90, v34
    v_xor_b32 v122, v35, v122
    v_cos_f32 v14, v18
    v_sin_f32_e64 v15, -v18
    v_add_f32 v18, v18, v19
    v_cvt_pk_bf16_f32 v91, v14, v15
    v_alignbit_b32 v123, v91, v91, v34
    v_xor_b32 v123, v35, v123
    v_cos_f32 v12, v18
    v_sin_f32_e64 v13, -v18
    v_add_f32 v18, v18, v17
    v_cvt_pk_bf16_f32 v92, v12, v13
    v_alignbit_b32 v124, v92, v92, v34
    v_xor_b32 v124, v35, v124
    v_cos_f32 v14, v18
    v_sin_f32_e64 v15, -v18
    v_add_f32 v18, v18, v17
    v_cvt_pk_bf16_f32 v93, v14, v15
    v_alignbit_b32 v125, v93, v93, v34
    v_xor_b32 v125, v35, v125
    v_cos_f32 v12, v18
    v_sin_f32_e64 v13, -v18
    v_add_f32 v18, v18, v17
    v_cvt_pk_bf16_f32 v94, v12, v13
    v_alignbit_b32 v126, v94, v94, v34
    v_xor_b32 v126, v35, v126
    v_cos_f32 v14, v18
    v_sin_f32_e64 v15, -v18
    v_add_f32 v18, v18, v19
    v_cvt_pk_bf16_f32 v95, v14, v15
    v_alignbit_b32 v127, v95, v95, v34
    v_xor_b32 v127, v35, v127
    v_bfe_u32 v4, v1, 2, 2
    v_lshl_add_u32 v5, v3, 3, v4
    v_lshlrev_b32 v5, 7, v5
    v_bfe_u32 v6, v1, 3, 1
    v_xor_b32 v6, s35, v6
    v_lshl_add_u32 v5, v6, 6, v5
    v_bfe_u32 v6, v1, 4, 1
    v_lshl_add_u32 v5, v6, 5, v5
    v_and_b32 v6, 3, v1
    v_lshl_add_u32 v5, v6, 3, v5
    s_lshl_b32 s4, s35, 14
    v_add_u32 v20, s4, v5
    v_xor_b32 v21, 64, v20
    s_cmp_lg_u32 s3, 0
    s_cbranch_scc1 WSK_14
    s_mov_b32 s60, 0x61a80
    s_mov_b64 exec, 0xff
POLL_15:
    buffer_load_dword v251, v250, s[84:87], s61 offen sc1
    s_waitcnt vmcnt(0)
    v_cmp_ne_u32 vcc, 32, v251
    s_sub_u32 s60, s60, 1
    s_cmp_eq_u32 s60, 0
    s_cbranch_scc1 PDN_16
    s_nop 1
    s_cbranch_vccz PDN_16
    s_sleep 1
    s_branch POLL_15
PDN_16:
    s_mov_b64 exec, -1
WSK_14:
    s_barrier
    s_lshl_b32 s4, s3, 19
    s_lshl_b32 s5, s56, 7
    s_add_u32 s4, s4, s5
    s_lshl_b32 s5, s3, 14
    s_add_u32 s6, s4, 0
    s_add_u32 m0, s5, 0
    s_nop 0
    buffer_load_dwordx4 v23, s[12:15], s6 offen sc1 lds
    s_add_u32 s6, s4, 0x8000
    s_add_u32 m0, s5, 0x400
    s_nop 0
    buffer_load_dwordx4 v23, s[12:15], s6 offen sc1 lds
    s_add_u32 s6, s4, 0x10000
    s_add_u32 m0, s5, 0x800
    s_nop 0
    buffer_load_dwordx4 v23, s[12:15], s6 offen sc1 lds
    s_add_u32 s6, s4, 0x18000
    s_add_u32 m0, s5, 0xc00
    s_nop 0
    buffer_load_dwordx4 v23, s[12:15], s6 offen sc1 lds
    s_add_u32 s6, s4, 0x20000
    s_add_u32 m0, s5, 0x1000
    s_nop 0
    buffer_load_dwordx4 v23, s[12:15], s6 offen sc1 lds
    s_add_u32 s6, s4, 0x28000
    s_add_u32 m0, s5, 0x1400
    s_nop 0
    buffer_load_dwordx4 v23, s[12:15], s6 offen sc1 lds
    s_add_u32 s6, s4, 0x30000
    s_add_u32 m0, s5, 0x1800
    s_nop 0
    buffer_load_dwordx4 v23, s[12:15], s6 offen sc1 lds
    s_add_u32 s6, s4, 0x38000
    s_add_u32 m0, s5, 0x1c00
    s_nop 0
    buffer_load_dwordx4 v23, s[12:15], s6 offen sc1 lds
    s_add_u32 s6, s4, 0x40000
    s_add_u32 m0, s5, 0x2000
    s_nop 0
    buffer_load_dwordx4 v23, s[12:15], s6 offen sc1 lds
    s_add_u32 s6, s4, 0x48000
    s_add_u32 m0, s5, 0x2400
    s_nop 0
    buffer_load_dwordx4 v23, s[12:15], s6 offen sc1 lds
    s_add_u32 s6, s4, 0x50000
    s_add_u32 m0, s5, 0x2800
    s_nop 0
    buffer_load_dwordx4 v23, s[12:15], s6 offen sc1 lds
    s_add_u32 s6, s4, 0x58000
    s_add_u32 m0, s5, 0x2c00
    s_nop 0
    buffer_load_dwordx4 v23, s[12:15], s6 offen sc1 lds
    s_add_u32 s6, s4, 0x60000
    s_add_u32 m0, s5, 0x3000
    s_nop 0
    buffer_load_dwordx4 v23, s[12:15], s6 offen sc1 lds
    s_add_u32 s6, s4, 0x68000
    s_add_u32 m0, s5, 0x3400
    s_nop 0
    buffer_load_dwordx4 v23, s[12:15], s6 offen sc1 lds
    s_add_u32 s6, s4, 0x70000
    s_add_u32 m0, s5, 0x3800
    s_nop 0
    buffer_load_dwordx4 v23, s[12:15], s6 offen sc1 lds
    s_add_u32 s6, s4, 0x78000
    s_add_u32 m0, s5, 0x3c00
    s_nop 0
    buffer_load_dwordx4 v23, s[12:15], s6 offen sc1 lds
    v_lshrrev_b32 v9, 5, v32
    v_lshl_add_u32 v9, v2, 6, v9
    v_lshlrev_b32 v9, 2, v9
    buffer_load_dword v22, v9, s[20:23], 0 offen sc1
    s_mul_i32 s6, s2, 0x1c00
    v_subrev_u32 v4, 64, v0
    v_cmp_gt_u32 vcc, 0x70, v4
    v_lshlrev_b32 v4, 6, v4
    v_mov_b32 v5, 0x7ff00000
    v_cndmask_b32 v4, v5, v4, vcc
    s_mov_b32 s28, s76
    s_mov_b32 s29, s77
    s_mov_b32 s30, 0x1c0000
    s_mov_b32 s31, 0x20000
    buffer_load_dword v209, v4, s[28:31], s6 offen
    s_waitcnt vmcnt(10)
    s_barrier
    ds_read_b64_tr_b16 v[160:161], v20 offset:0
    ds_read_b64_tr_b16 v[162:163], v20 offset:512
    ds_read_b64_tr_b16 v[164:165], v21 offset:0
    ds_read_b64_tr_b16 v[166:167], v21 offset:512
    ds_read_b64_tr_b16 v[168:169], v20 offset:2048
    ds_read_b64_tr_b16 v[170:171], v20 offset:2560
    ds_read_b64_tr_b16 v[172:173], v21 offset:2048
    ds_read_b64_tr_b16 v[174:175], v21 offset:2560
    s_waitcnt lgkmcnt(4)
    v_mfma_f32_32x32x16_bf16 v[128:143], v[64:67], v[160:163], 0
    v_mfma_f32_32x32x16_bf16 v[144:159], v[64:67], v[164:167], 0
    ds_read_b64_tr_b16 v[160:161], v20 offset:4096
    ds_read_b64_tr_b16 v[162:163], v20 offset:4608
    ds_read_b64_tr_b16 v[164:165], v21 offset:4096
    ds_read_b64_tr_b16 v[166:167], v21 offset:4608
    s_waitcnt lgkmcnt(4)
    v_mfma_f32_32x32x16_bf16 v[128:143], v[68:71], v[168:171], v[128:143]
    v_mfma_f32_32x32x16_bf16 v[144:159], v[68:71], v[172:175], v[144:159]
    ds_read_b64_tr_b16 v[168:169], v20 offset:6144
    ds_read_b64_tr_b16 v[170:171], v20 offset:6656
    ds_read_b64_tr_b16 v[172:173], v21 offset:6144
    ds_read_b64_tr_b16 v[174:175], v21 offset:6656
    s_waitcnt lgkmcnt(4)
    v_mfma_f32_32x32x16_bf16 v[128:143], v[72:75], v[160:163], v[128:143]
    v_mfma_f32_32x32x16_bf16 v[144:159], v[72:75], v[164:167], v[144:159]
    ds_read_b64_tr_b16 v[160:161], v20 offset:32768
    ds_read_b64_tr_b16 v[162:163], v20 offset:33280
    ds_read_b64_tr_b16 v[164:165], v21 offset:32768
    ds_read_b64_tr_b16 v[166:167], v21 offset:33280
    s_waitcnt lgkmcnt(4)
    v_mfma_f32_32x32x16_bf16 v[128:143], v[76:79], v[168:171], v[128:143]
    v_mfma_f32_32x32x16_bf16 v[144:159], v[76:79], v[172:175], v[144:159]
    ds_read_b64_tr_b16 v[168:169], v20 offset:34816
    ds_read_b64_tr_b16 v[170:171], v20 offset:35328
    ds_read_b64_tr_b16 v[172:173], v21 offset:34816
    ds_read_b64_tr_b16 v[174:175], v21 offset:35328
    s_waitcnt lgkmcnt(4)
    v_mfma_f32_32x32x16_bf16 v[128:143], v[96:99], v[160:163], v[128:143]
    v_mfma_f32_32x32x16_bf16 v[144:159], v[96:99], v[164:167], v[144:159]
    ds_read_b64_tr_b16 v[160:161], v20 offset:36864
    ds_read_b64_tr_b16 v[162:163], v20 offset:37376
    ds_read_b64_tr_b16 v[164:165], v21 offset:36864
    ds_read_b64_tr_b16 v[166:167], v21 offset:37376
    s_waitcnt lgkmcnt(4)
    v_mfma_f32_32x32x16_bf16 v[128:143], v[100:103], v[168:171], v[128:143]
    v_mfma_f32_32x32x16_bf16 v[144:159], v[100:103], v[172:175], v[144:159]
    ds_read_b64_tr_b16 v[168:169], v20 offset:38912
    ds_read_b64_tr_b16 v[170:171], v20 offset:39424
    ds_read_b64_tr_b16 v[172:173], v21 offset:38912
    ds_read_b64_tr_b16 v[174:175], v21 offset:39424
    s_waitcnt lgkmcnt(4)
    v_mfma_f32_32x32x16_bf16 v[128:143], v[104:107], v[160:163], v[128:143]
    v_mfma_f32_32x32x16_bf16 v[144:159], v[104:107], v[164:167], v[144:159]
    s_waitcnt lgkmcnt(0)
    v_mfma_f32_32x32x16_bf16 v[128:143], v[108:111], v[168:171], v[128:143]
    v_mfma_f32_32x32x16_bf16 v[144:159], v[108:111], v[172:175], v[144:159]
    s_waitcnt vmcnt(2)
    s_barrier
    ds_read_b64_tr_b16 v[160:161], v20 offset:8192
    ds_read_b64_tr_b16 v[162:163], v20 offset:8704
    ds_read_b64_tr_b16 v[164:165], v21 offset:8192
    ds_read_b64_tr_b16 v[166:167], v21 offset:8704
    ds_read_b64_tr_b16 v[168:169], v20 offset:10240
    ds_read_b64_tr_b16 v[170:171], v20 offset:10752
    ds_read_b64_tr_b16 v[172:173], v21 offset:10240
    ds_read_b64_tr_b16 v[174:175], v21 offset:10752
    s_waitcnt lgkmcnt(4)
    v_mfma_f32_32x32x16_bf16 v[128:143], v[80:83], v[160:163], v[128:143]
    v_mfma_f32_32x32x16_bf16 v[144:159], v[80:83], v[164:167], v[144:159]
    s_add_u32 s62, s53, 0x70000
    s_add_u32 m0, s52, 0x1e200
    s_nop 0
    buffer_load_dwordx4 v240, s[48:51], s62 offen lds
    ds_read_b64_tr_b16 v[160:161], v20 offset:12288
    ds_read_b64_tr_b16 v[162:163], v20 offset:12800
    ds_read_b64_tr_b16 v[164:165], v21 offset:12288
    ds_read_b64_tr_b16 v[166:167], v21 offset:12800
    s_waitcnt lgkmcnt(4)
    v_mfma_f32_32x32x16_bf16 v[128:143], v[84:87], v[168:171], v[128:143]
    v_mfma_f32_32x32x16_bf16 v[144:159], v[84:87], v[172:175], v[144:159]
    s_add_u32 m0, s52, 0x1e200
    s_nop 0
    buffer_load_dwordx4 v241, s[48:51], s62 offen offset:1024 lds
    ds_read_b64_tr_b16 v[168:169], v20 offset:14336
    ds_read_b64_tr_b16 v[170:171], v20 offset:14848
    ds_read_b64_tr_b16 v[172:173], v21 offset:14336
    ds_read_b64_tr_b16 v[174:175], v21 offset:14848
    s_waitcnt lgkmcnt(4)
    v_mfma_f32_32x32x16_bf16 v[128:143], v[88:91], v[160:163], v[128:143]
    v_mfma_f32_32x32x16_bf16 v[144:159], v[88:91], v[164:167], v[144:159]
    s_add_u32 m0, s52, 0x1e200
    s_nop 0
    buffer_load_dwordx4 v242, s[48:51], s62 offen offset:2048 lds
    ds_read_b64_tr_b16 v[160:161], v20 offset:40960
    ds_read_b64_tr_b16 v[162:163], v20 offset:41472
    ds_read_b64_tr_b16 v[164:165], v21 offset:40960
    ds_read_b64_tr_b16 v[166:167], v21 offset:41472
    s_waitcnt lgkmcnt(4)
    v_mfma_f32_32x32x16_bf16 v[128:143], v[92:95], v[168:171], v[128:143]
    v_mfma_f32_32x32x16_bf16 v[144:159], v[92:95], v[172:175], v[144:159]
    s_add_u32 m0, s52, 0x1e200
    s_nop 0
    buffer_load_dwordx4 v243, s[48:51], s62 offen offset:3072 lds
    ds_read_b64_tr_b16 v[168:169], v20 offset:43008
    ds_read_b64_tr_b16 v[170:171], v20 offset:43520
    ds_read_b64_tr_b16 v[172:173], v21 offset:43008
    ds_read_b64_tr_b16 v[174:175], v21 offset:43520
    s_waitcnt lgkmcnt(4)
    v_mfma_f32_32x32x16_bf16 v[128:143], v[112:115], v[160:163], v[128:143]
    v_mfma_f32_32x32x16_bf16 v[144:159], v[112:115], v[164:167], v[144:159]
    s_add_u32 m0, s52, 0x1f200
    s_nop 0
    buffer_load_dwordx4 v244, s[48:51], s62 offen lds
    ds_read_b64_tr_b16 v[160:161], v20 offset:45056
    ds_read_b64_tr_b16 v[162:163], v20 offset:45568
    ds_read_b64_tr_b16 v[164:165], v21 offset:45056
    ds_read_b64_tr_b16 v[166:167], v21 offset:45568
    s_waitcnt lgkmcnt(4)
    v_mfma_f32_32x32x16_bf16 v[128:143], v[116:119], v[168:171], v[128:143]
    v_mfma_f32_32x32x16_bf16 v[144:159], v[116:119], v[172:175], v[144:159]
    s_add_u32 m0, s52, 0x1f200
    s_nop 0
    buffer_load_dwordx4 v245, s[48:51], s62 offen offset:1024 lds
    ds_read_b64_tr_b16 v[168:169], v20 offset:47104
    ds_read_b64_tr_b16 v[170:171], v20 offset:47616
    ds_read_b64_tr_b16 v[172:173], v21 offset:47104
    ds_read_b64_tr_b16 v[174:175], v21 offset:47616
    s_waitcnt lgkmcnt(4)
    v_mfma_f32_32x32x16_bf16 v[128:143], v[120:123], v[160:163], v[128:143]
    v_mfma_f32_32x32x16_bf16 v[144:159], v[120:123], v[164:167], v[144:159]
    s_add_u32 m0, s52, 0x1f200
    s_nop 0
    buffer_load_dwordx4 v246, s[48:51], s62 offen offset:2048 lds
    s_waitcnt lgkmcnt(0)
    v_mfma_f32_32x32x16_bf16 v[128:143], v[124:127], v[168:171], v[128:143]
    v_mfma_f32_32x32x16_bf16 v[144:159], v[124:127], v[172:175], v[144:159]
    s_barrier
    s_lshl_b32 s4, s3, 12
    s_add_u32 s4, s4, 0
    v_add_u32 v5, s4, v16
    s_nop 7
    ds_write_b128 v5, v[144:147] offset:0
    ds_write_b128 v5, v[148:151] offset:1024
    ds_write_b128 v5, v[152:155] offset:2048
    ds_write_b128 v5, v[156:159] offset:3072
    s_waitcnt lgkmcnt(0)
    s_barrier
    v_xor_b32 v5, 0x2000, v5
    ds_read_b128 v[144:147], v5 offset:0
    ds_read_b128 v[148:151], v5 offset:1024
    ds_read_b128 v[152:155], v5 offset:2048
    ds_read_b128 v[156:159], v5 offset:3072
    s_waitcnt vmcnt(8)
    s_waitcnt lgkmcnt(0)
    v_mov_b32 v9, v22
    v_mov_b32 v8, v22
    v_lshlrev_b32 v6, 16, v24
    v_and_b32 v7, 0xffff0000, v24
    v_pk_add_f32 v[128:129], v[128:129], v[144:145]
    v_pk_add_f32 v[224:225], v[128:129], v[6:7]
    v_pk_add_f32 v[128:129], v[224:225], v[8:9] neg_lo:[0,1] neg_hi:[0,1]
    v_cvt_pk_bf16_f32 v176, v128, v129
    v_lshlrev_b32 v10, 16, v25
    v_and_b32 v11, 0xffff0000, v25
    v_pk_add_f32 v[130:131], v[130:131], v[146:147]
    v_pk_add_f32 v[226:227], v[130:131], v[10:11]
    v_pk_add_f32 v[130:131], v[226:227], v[8:9] neg_lo:[0,1] neg_hi:[0,1]
    v_cvt_pk_bf16_f32 v177, v130, v131
    v_lshlrev_b32 v6, 16, v26
    v_and_b32 v7, 0xffff0000, v26
    v_pk_add_f32 v[132:133], v[132:133], v[148:149]
    v_pk_add_f32 v[228:229], v[132:133], v[6:7]
    v_pk_add_f32 v[132:133], v[228:229], v[8:9] neg_lo:[0,1] neg_hi:[0,1]
    v_cvt_pk_bf16_f32 v178, v132, v133
    v_lshlrev_b32 v10, 16, v27
    v_and_b32 v11, 0xffff0000, v27
    v_pk_add_f32 v[134:135], v[134:135], v[150:151]
    v_pk_add_f32 v[230:231], v[134:135], v[10:11]
    v_pk_add_f32 v[134:135], v[230:231], v[8:9] neg_lo:[0,1] neg_hi:[0,1]
    v_cvt_pk_bf16_f32 v179, v134, v135
    v_lshlrev_b32 v6, 16, v28
    v_and_b32 v7, 0xffff0000, v28
    v_pk_add_f32 v[136:137], v[136:137], v[152:153]
    v_pk_add_f32 v[232:233], v[136:137], v[6:7]
    v_pk_add_f32 v[136:137], v[232:233], v[8:9] neg_lo:[0,1] neg_hi:[0,1]
    v_cvt_pk_bf16_f32 v180, v136, v137
    v_lshlrev_b32 v10, 16, v29
    v_and_b32 v11, 0xffff0000, v29
    v_pk_add_f32 v[138:139], v[138:139], v[154:155]
    v_pk_add_f32 v[234:235], v[138:139], v[10:11]
    v_pk_add_f32 v[138:139], v[234:235], v[8:9] neg_lo:[0,1] neg_hi:[0,1]
    v_cvt_pk_bf16_f32 v181, v138, v139
    v_lshlrev_b32 v6, 16, v30
    v_and_b32 v7, 0xffff0000, v30
    v_pk_add_f32 v[140:141], v[140:141], v[156:157]
    v_pk_add_f32 v[236:237], v[140:141], v[6:7]
    v_pk_add_f32 v[140:141], v[236:237], v[8:9] neg_lo:[0,1] neg_hi:[0,1]
    v_cvt_pk_bf16_f32 v182, v140, v141
    v_lshlrev_b32 v10, 16, v31
    v_and_b32 v11, 0xffff0000, v31
    v_pk_add_f32 v[142:143], v[142:143], v[158:159]
    v_pk_add_f32 v[238:239], v[142:143], v[10:11]
    v_pk_add_f32 v[142:143], v[238:239], v[8:9] neg_lo:[0,1] neg_hi:[0,1]
    v_cvt_pk_bf16_f32 v183, v142, v143
    s_lshl_b32 s4, s56, 1
    s_add_u32 s4, s4, s35
    s_lshl_b32 s4, s4, 5
    s_lshl_b32 s5, s57, 1
    s_add_u32 s5, s5, s34
    s_lshl_b32 s6, s5, 1
    s_add_u32 s4, s4, s6
    s_lshl_b32 s4, s4, 10
    buffer_store_dwordx4 v[176:179], v16, s[16:19], s4 offen sc1
    buffer_store_dwordx4 v[180:183], v16, s[16:19], s4 offen offset:1024 sc1
    v_mul_f32 v6, v128, v128
    v_fma_f32 v6, v129, v129, v6
    v_fma_f32 v6, v130, v130, v6
    v_fma_f32 v6, v131, v131, v6
    v_fma_f32 v6, v132, v132, v6
    v_fma_f32 v6, v133, v133, v6
    v_fma_f32 v6, v134, v134, v6
    v_fma_f32 v6, v135, v135, v6
    v_fma_f32 v6, v136, v136, v6
    v_fma_f32 v6, v137, v137, v6
    v_fma_f32 v6, v138, v138, v6
    v_fma_f32 v6, v139, v139, v6
    v_fma_f32 v6, v140, v140, v6
    v_fma_f32 v6, v141, v141, v6
    v_fma_f32 v6, v142, v142, v6
    v_fma_f32 v6, v143, v143, v6
    v_mov_b32 v7, v6
    s_nop 1
    v_permlane32_swap_b32 v6, v7
    v_add_f32 v6, v6, v7
    v_lshlrev_b32 v8, 2, v2
    s_lshl_b32 s4, s56, 1
    s_add_u32 s4, s4, s35
    s_lshl_b32 s4, s4, 11
    s_lshl_b32 s5, s5, 7
    s_add_u32 s5, s5, s4
    s_mov_b32 exec_hi, 0
    buffer_store_dword v6, v8, s[24:27], s5 offen sc1
    s_mov_b64 exec, -1
    s_lshr_b32 s42, s56, 1
    s_add_u32 s42, s42, 16
    s_waitcnt vmcnt(0)
    s_barrier
    s_cmp_lg_u32 s3, 0
    s_cbranch_scc1 ARR_17
    s_lshl_b32 s60, s42, 8
    v_mov_b32 v253, 0
    v_mov_b32 v254, 1
    s_mov_b64 exec, 1
    buffer_atomic_add v254, v253, s[84:87], s60 offen sc1
    s_mov_b64 exec, -1
ARR_17:
    v_lshlrev_b32 v2, 4, v1
    s_add_u32 s8, s82, 0x600000
    s_addc_u32 s9, s83, 0
    s_mov_b32 s10, 0x200000
    s_mov_b32 s11, 0x20000
    s_add_u32 s12, s82, 0x800000
    s_addc_u32 s13, s83, 0
    s_mov_b32 s14, 0x700000
    s_mov_b32 s15, 0x20000
    s_lshl_b32 s32, s54, 2
    s_add_u32 s32, s32, s3
    s_lshl_b32 s33, s32, 15
    v_bfe_u32 v4, v1, 1, 1
    v_mul_u32_u24 v4, 0x3880, v4
    v_lshrrev_b32 v5, 5, v1
    v_lshlrev_b32 v5, 4, v5
    v_bfe_u32 v6, v1, 2, 2
    v_add_u32 v5, v5, v6
    v_mul_u32_u24 v5, 0xe0, v5
    v_add_u32 v4, v4, v5
    v_and_b32 v5, 1, v1
    v_lshl_add_u32 v4, v5, 4, v4
    v_bfe_u32 v5, v1, 4, 1
    v_lshl_add_u32 v4, v5, 3, v4
    v_add_u32 v20, 0x10000, v4
    s_add_u32 s42, s54, 16
    s_lshl_b32 s61, s42, 8
    s_cmp_eq_u32 s3, 0
    s_cselect_b32 s60, 0, 0x7ff00000
    v_lshlrev_b32 v250, 8, v1
    v_add_u32 v250, s60, v250
    s_add_u32 s62, s53, 0xa8000
    s_add_u32 m0, s52, 0
    s_nop 0
    buffer_load_dwordx4 v240, s[48:51], s62 offen lds
    s_add_u32 m0, s52, 0
    s_nop 0
    buffer_load_dwordx4 v241, s[48:51], s62 offen offset:1024 lds
    s_add_u32 m0, s52, 0
    s_nop 0
    buffer_load_dwordx4 v242, s[48:51], s62 offen offset:2048 lds
    s_add_u32 m0, s52, 0
    s_nop 0
    buffer_load_dwordx4 v243, s[48:51], s62 offen offset:3072 lds
    s_add_u32 m0, s52, 0x1000
    s_nop 0
    buffer_load_dwordx4 v244, s[48:51], s62 offen lds
    s_add_u32 m0, s52, 0x1000
    s_nop 0
    buffer_load_dwordx4 v245, s[48:51], s62 offen offset:1024 lds
    s_add_u32 m0, s52, 0x1000
    s_nop 0
    buffer_load_dwordx4 v246, s[48:51], s62 offen offset:2048 lds
    s_mov_b64 exec, 1
    buffer_load_dword v252, v250, s[84:87], s61 offen sc1
    s_mov_b64 exec, -1
    s_add_u32 s62, s53, 0xe0000
    s_add_u32 m0, s52, 0x7100
    s_nop 0
    buffer_load_dwordx4 v240, s[48:51], s62 offen lds
    s_add_u32 m0, s52, 0x7100
    s_nop 0
    buffer_load_dwordx4 v241, s[48:51], s62 offen offset:1024 lds
    s_add_u32 m0, s52, 0x7100
    s_nop 0
    buffer_load_dwordx4 v242, s[48:51], s62 offen offset:2048 lds
    s_add_u32 m0, s52, 0x7100
    s_nop 0
    buffer_load_dwordx4 v243, s[48:51], s62 offen offset:3072 lds
    s_add_u32 m0, s52, 0x8100
    s_nop 0
    buffer_load_dwordx4 v244, s[48:51], s62 offen lds
    s_add_u32 m0, s52, 0x8100
    s_nop 0
    buffer_load_dwordx4 v245, s[48:51], s62 offen offset:1024 lds
    s_add_u32 m0, s52, 0x8100
    s_nop 0
    buffer_load_dwordx4 v246, s[48:51], s62 offen offset:2048 lds
    s_mov_b32 s28, s76
    s_mov_b32 s29, s77
    s_mov_b32 s30, 0x1c0000
    s_mov_b32 s31, 0x20000
    v_lshrrev_b32 v9, 3, v1
    v_bfe_u32 v10, v1, 4, 1
    v_lshlrev_b32 v10, 2, v10
    v_and_b32 v11, 7, v1
    v_xor_b32 v10, v10, v11
    v_lshlrev_b32 v10, 4, v10
    v_lshl_add_u32 v248, v9, 10, v10
    v_add_u32 v249, 0x1c00, v248
    s_mul_i32 s58, s3, 0x70000
    s_lshl_b32 s4, s57, 7
    s_add_u32 s58, s58, s4
    s_lshl_b32 s59, s3, 11
    s_cmp_lg_u32 s3, 0
    s_cbranch_scc1 WSK_18
    s_mov_b32 s60, 0x61a80
    s_mov_b64 exec, 1
    s_waitcnt vmcnt(7)
    v_cmp_ne_u32 vcc, 16, v252
    s_nop 4
    s_cbranch_vccz PDN_20
POLL_19:
    buffer_load_dword v251, v250, s[84:87], s61 offen sc1
    s_waitcnt vmcnt(0)
    v_cmp_ne_u32 vcc, 16, v251
    s_sub_u32 s60, s60, 1
    s_cmp_eq_u32 s60, 0
    s_cbranch_scc1 PDN_20
    s_nop 1
    s_cbranch_vccz PDN_20
    s_sleep 1
    s_branch POLL_19
PDN_20:
    s_mov_b64 exec, -1
WSK_18:
    s_barrier
    ds_read_b64_tr_b16 v[32:33], v20 offset:0
    ds_read_b64_tr_b16 v[34:35], v20 offset:896
    ds_read_b64_tr_b16 v[36:37], v20 offset:32
    ds_read_b64_tr_b16 v[38:39], v20 offset:928
    ds_read_b64_tr_b16 v[40:41], v20 offset:64
    ds_read_b64_tr_b16 v[42:43], v20 offset:960
    ds_read_b64_tr_b16 v[44:45], v20 offset:96
    ds_read_b64_tr_b16 v[46:47], v20 offset:992
    ds_read_b64_tr_b16 v[48:49], v20 offset:128
    ds_read_b64_tr_b16 v[50:51], v20 offset:1024
    ds_read_b64_tr_b16 v[52:53], v20 offset:160
    ds_read_b64_tr_b16 v[54:55], v20 offset:1056
    ds_read_b64_tr_b16 v[56:57], v20 offset:192
    ds_read_b64_tr_b16 v[58:59], v20 offset:1088
    s_add_u32 s34, s33, 0
    buffer_load_dwordx4 a[0:3], v2, s[8:11], s34 offen sc1
    buffer_load_dwordx4 a[4:7], v2, s[8:11], s34 offen offset:1024 sc1
    buffer_load_dwordx4 a[8:11], v2, s[8:11], s34 offen offset:2048 sc1
    buffer_load_dwordx4 a[12:15], v2, s[8:11], s34 offen offset:3072 sc1
    s_add_u32 s34, s33, 0x1000
    buffer_load_dwordx4 a[16:19], v2, s[8:11], s34 offen sc1
    buffer_load_dwordx4 a[20:23], v2, s[8:11], s34 offen offset:1024 sc1
    buffer_load_dwordx4 a[24:27], v2, s[8:11], s34 offen offset:2048 sc1
    buffer_load_dwordx4 a[28:31], v2, s[8:11], s34 offen offset:3072 sc1
    s_waitcnt vmcnt(7)
    s_waitcnt lgkmcnt(10)
    v_mfma_f32_32x32x16_bf16 v[104:119], v[32:35], a[0:3], 0
    ds_read_b64_tr_b16 v[64:65], v20 offset:1792
    ds_read_b64_tr_b16 v[66:67], v20 offset:2688
    v_mfma_f32_32x32x16_bf16 v[120:135], v[36:39], a[0:3], 0
    ds_read_b64_tr_b16 v[68:69], v20 offset:1824
    ds_read_b64_tr_b16 v[70:71], v20 offset:2720
    s_add_u32 s34, s33, 0x2000
    buffer_load_dwordx4 a[32:35], v2, s[8:11], s34 offen sc1
    s_waitcnt lgkmcnt(10)
    v_mfma_f32_32x32x16_bf16 v[136:151], v[40:43], a[0:3], 0
    ds_read_b64_tr_b16 v[72:73], v20 offset:1856
    ds_read_b64_tr_b16 v[74:75], v20 offset:2752
    v_mfma_f32_32x32x16_bf16 v[152:167], v[44:47], a[0:3], 0
    ds_read_b64_tr_b16 v[76:77], v20 offset:1888
    ds_read_b64_tr_b16 v[78:79], v20 offset:2784
    buffer_load_dwordx4 a[36:39], v2, s[8:11], s34 offen offset:1024 sc1
    s_waitcnt lgkmcnt(10)
    v_mfma_f32_32x32x16_bf16 v[168:183], v[48:51], a[0:3], 0
    ds_read_b64_tr_b16 v[80:81], v20 offset:1920
    ds_read_b64_tr_b16 v[82:83], v20 offset:2816
    v_mfma_f32_32x32x16_bf16 v[184:199], v[52:55], a[0:3], 0
    ds_read_b64_tr_b16 v[84:85], v20 offset:1952
    ds_read_b64_tr_b16 v[86:87], v20 offset:2848
    buffer_load_dwordx4 a[40:43], v2, s[8:11], s34 offen offset:2048 sc1
    s_waitcnt lgkmcnt(12)
    v_mfma_f32_32x32x16_bf16 v[200:215], v[56:59], a[0:3], 0
    ds_read_b64_tr_b16 v[88:89], v20 offset:1984
    ds_read_b64_tr_b16 v[90:91], v20 offset:2880
    s_waitcnt vmcnt(9)
    s_waitcnt lgkmcnt(10)
    v_mfma_f32_32x32x16_bf16 v[104:119], v[64:67], a[4:7], v[104:119]
    ds_read_b64_tr_b16 v[32:33], v20 offset:7168
    ds_read_b64_tr_b16 v[34:35], v20 offset:8064
    v_mfma_f32_32x32x16_bf16 v[120:135], v[68:71], a[4:7], v[120:135]
    ds_read_b64_tr_b16 v[36:37], v20 offset:7200
    ds_read_b64_tr_b16 v[38:39], v20 offset:8096
    buffer_load_dwordx4 a[44:47], v2, s[8:11], s34 offen offset:3072 sc1
    s_waitcnt lgkmcnt(10)
    v_mfma_f32_32x32x16_bf16 v[136:151], v[72:75], a[4:7], v[136:151]
    ds_read_b64_tr_b16 v[40:41], v20 offset:7232
    ds_read_b64_tr_b16 v[42:43], v20 offset:8128
    v_mfma_f32_32x32x16_bf16 v[152:167], v[76:79], a[4:7], v[152:167]
    ds_read_b64_tr_b16 v[44:45], v20 offset:7264
    ds_read_b64_tr_b16 v[46:47], v20 offset:8160
    s_add_u32 s34, s33, 0x3000
    buffer_load_dwordx4 a[48:51], v2, s[8:11], s34 offen sc1
    s_waitcnt lgkmcnt(10)
    v_mfma_f32_32x32x16_bf16 v[168:183], v[80:83], a[4:7], v[168:183]
    ds_read_b64_tr_b16 v[48:49], v20 offset:7296
    ds_read_b64_tr_b16 v[50:51], v20 offset:8192
    v_mfma_f32_32x32x16_bf16 v[184:199], v[84:87], a[4:7], v[184:199]
    ds_read_b64_tr_b16 v[52:53], v20 offset:7328
    ds_read_b64_tr_b16 v[54:55], v20 offset:8224
    buffer_load_dwordx4 a[52:55], v2, s[8:11], s34 offen offset:1024 sc1
    s_waitcnt lgkmcnt(12)
    v_mfma_f32_32x32x16_bf16 v[200:215], v[88:91], a[4:7], v[200:215]
    ds_read_b64_tr_b16 v[56:57], v20 offset:7360
    ds_read_b64_tr_b16 v[58:59], v20 offset:8256
    s_waitcnt vmcnt(11)
    s_waitcnt lgkmcnt(10)
    v_mfma_f32_32x32x16_bf16 v[104:119], v[32:35], a[8:11], v[104:119]
    ds_read_b64_tr_b16 v[64:65], v20 offset:8960
    ds_read_b64_tr_b16 v[66:67], v20 offset:9856
    v_mfma_f32_32x32x16_bf16 v[120:135], v[36:39], a[8:11], v[120:135]
    ds_read_b64_tr_b16 v[68:69], v20 offset:8992
    ds_read_b64_tr_b16 v[70:71], v20 offset:9888
    buffer_load_dwordx4 a[56:59], v2, s[8:11], s34 offen offset:2048 sc1
    s_waitcnt lgkmcnt(10)
    v_mfma_f32_32x32x16_bf16 v[136:151], v[40:43], a[8:11], v[136:151]
    ds_read_b64_tr_b16 v[72:73], v20 offset:9024
    ds_read_b64_tr_b16 v[74:75], v20 offset:9920
    v_mfma_f32_32x32x16_bf16 v[152:167], v[44:47], a[8:11], v[152:167]
    ds_read_b64_tr_b16 v[76:77], v20 offset:9056
    ds_read_b64_tr_b16 v[78:79], v20 offset:9952
    buffer_load_dwordx4 a[60:63], v2, s[8:11], s34 offen offset:3072 sc1
    s_waitcnt lgkmcnt(10)
    v_mfma_f32_32x32x16_bf16 v[168:183], v[48:51], a[8:11], v[168:183]
    ds_read_b64_tr_b16 v[80:81], v20 offset:9088
    ds_read_b64_tr_b16 v[82:83], v20 offset:9984
    v_mfma_f32_32x32x16_bf16 v[184:199], v[52:55], a[8:11], v[184:199]
    ds_read_b64_tr_b16 v[84:85], v20 offset:9120
    ds_read_b64_tr_b16 v[86:87], v20 offset:10016
    s_add_u32 s34, s33, 0x4000
    buffer_load_dwordx4 a[64:67], v2, s[8:11], s34 offen sc1
    s_waitcnt lgkmcnt(12)
    v_mfma_f32_32x32x16_bf16 v[200:215], v[56:59], a[8:11], v[200:215]
    ds_read_b64_tr_b16 v[88:89], v20 offset:9152
    ds_read_b64_tr_b16 v[90:91], v20 offset:10048
    s_barrier
    v_add_u32 v21, 0x7100, v20
    s_waitcnt vmcnt(13)
    s_waitcnt lgkmcnt(10)
    v_mfma_f32_32x32x16_bf16 v[104:119], v[64:67], a[12:15], v[104:119]
    ds_read_b64_tr_b16 v[32:33], v21 offset:0
    ds_read_b64_tr_b16 v[34:35], v21 offset:896
    v_mfma_f32_32x32x16_bf16 v[120:135], v[68:71], a[12:15], v[120:135]
    ds_read_b64_tr_b16 v[36:37], v21 offset:32
    ds_read_b64_tr_b16 v[38:39], v21 offset:928
    buffer_load_dwordx4 a[68:71], v2, s[8:11], s34 offen offset:1024 sc1
    s_waitcnt lgkmcnt(10)
    v_mfma_f32_32x32x16_bf16 v[136:151], v[72:75], a[12:15], v[136:151]
    ds_read_b64_tr_b16 v[40:41], v21 offset:64
    ds_read_b64_tr_b16 v[42:43], v21 offset:960
    v_mfma_f32_32x32x16_bf16 v[152:167], v[76:79], a[12:15], v[152:167]
    ds_read_b64_tr_b16 v[44:45], v21 offset:96
    ds_read_b64_tr_b16 v[46:47], v21 offset:992
    buffer_load_dwordx4 a[72:75], v2, s[8:11], s34 offen offset:2048 sc1
    s_waitcnt lgkmcnt(10)
    v_mfma_f32_32x32x16_bf16 v[168:183], v[80:83], a[12:15], v[168:183]
    ds_read_b64_tr_b16 v[48:49], v21 offset:128
    ds_read_b64_tr_b16 v[50:51], v21 offset:1024
    v_mfma_f32_32x32x16_bf16 v[184:199], v[84:87], a[12:15], v[184:199]
    ds_read_b64_tr_b16 v[52:53], v21 offset:160
    ds_read_b64_tr_b16 v[54:55], v21 offset:1056
    buffer_load_dwordx4 a[76:79], v2, s[8:11], s34 offen offset:3072 sc1
    s_waitcnt lgkmcnt(12)
    v_mfma_f32_32x32x16_bf16 v[200:215], v[88:91], a[12:15], v[200:215]
    ds_read_b64_tr_b16 v[56:57], v21 offset:192
    ds_read_b64_tr_b16 v[58:59], v21 offset:1088
    v_mov_b32 v20, v21
    s_waitcnt vmcnt(15)
    s_waitcnt lgkmcnt(10)
    v_mfma_f32_32x32x16_bf16 v[104:119], v[32:35], a[16:19], v[104:119]
    ds_read_b64_tr_b16 v[64:65], v20 offset:1792
    ds_read_b64_tr_b16 v[66:67], v20 offset:2688
    v_mfma_f32_32x32x16_bf16 v[120:135], v[36:39], a[16:19], v[120:135]
    ds_read_b64_tr_b16 v[68:69], v20 offset:1824
    ds_read_b64_tr_b16 v[70:71], v20 offset:2720
    s_waitcnt lgkmcnt(10)
    v_mfma_f32_32x32x16_bf16 v[136:151], v[40:43], a[16:19], v[136:151]
    ds_read_b64_tr_b16 v[72:73], v20 offset:1856
    ds_read_b64_tr_b16 v[74:75], v20 offset:2752
    v_mfma_f32_32x32x16_bf16 v[152:167], v[44:47], a[16:19], v[152:167]
    ds_read_b64_tr_b16 v[76:77], v20 offset:1888
    ds_read_b64_tr_b16 v[78:79], v20 offset:2784
    s_waitcnt lgkmcnt(10)
    v_mfma_f32_32x32x16_bf16 v[168:183], v[48:51], a[16:19], v[168:183]
    ds_read_b64_tr_b16 v[80:81], v20 offset:1920
    ds_read_b64_tr_b16 v[82:83], v20 offset:2816
    v_mfma_f32_32x32x16_bf16 v[184:199], v[52:55], a[16:19], v[184:199]
    ds_read_b64_tr_b16 v[84:85], v20 offset:1952
    ds_read_b64_tr_b16 v[86:87], v20 offset:2848
    s_waitcnt lgkmcnt(12)
    v_mfma_f32_32x32x16_bf16 v[200:215], v[56:59], a[16:19], v[200:215]
    ds_read_b64_tr_b16 v[88:89], v20 offset:1984
    ds_read_b64_tr_b16 v[90:91], v20 offset:2880
    s_waitcnt vmcnt(14)
    s_waitcnt lgkmcnt(10)
    v_mfma_f32_32x32x16_bf16 v[104:119], v[64:67], a[20:23], v[104:119]
    ds_read_b64_tr_b16 v[32:33], v20 offset:7168
    ds_read_b64_tr_b16 v[34:35], v20 offset:8064
    v_mfma_f32_32x32x16_bf16 v[120:135], v[68:71], a[20:23], v[120:135]
    ds_read_b64_tr_b16 v[36:37], v20 offset:7200
    ds_read_b64_tr_b16 v[38:39], v20 offset:8096
    s_waitcnt lgkmcnt(10)
    v_mfma_f32_32x32x16_bf16 v[136:151], v[72:75], a[20:23], v[136:151]
    ds_read_b64_tr_b16 v[40:41], v20 offset:7232
    ds_read_b64_tr_b16 v[42:43], v20 offset:8128
    v_mfma_f32_32x32x16_bf16 v[152:167], v[76:79], a[20:23], v[152:167]
    ds_read_b64_tr_b16 v[44:45], v20 offset:7264
    ds_read_b64_tr_b16 v[46:47], v20 offset:8160
    s_waitcnt lgkmcnt(10)
    v_mfma_f32_32x32x16_bf16 v[168:183], v[80:83], a[20:23], v[168:183]
    ds_read_b64_tr_b16 v[48:49], v20 offset:7296
    ds_read_b64_tr_b16 v[50:51], v20 offset:8192
    v_mfma_f32_32x32x16_bf16 v[184:199], v[84:87], a[20:23], v[184:199]
    ds_read_b64_tr_b16 v[52:53], v20 offset:7328
    ds_read_b64_tr_b16 v[54:55], v20 offset:8224
    s_waitcnt lgkmcnt(12)
    v_mfma_f32_32x32x16_bf16 v[200:215], v[88:91], a[20:23], v[200:215]
    ds_read_b64_tr_b16 v[56:57], v20 offset:7360
    ds_read_b64_tr_b16 v[58:59], v20 offset:8256
    s_waitcnt vmcnt(13)
    s_waitcnt lgkmcnt(10)
    v_mfma_f32_32x32x16_bf16 v[104:119], v[32:35], a[24:27], v[104:119]
    ds_read_b64_tr_b16 v[64:65], v20 offset:8960
    ds_read_b64_tr_b16 v[66:67], v20 offset:9856
    v_mfma_f32_32x32x16_bf16 v[120:135], v[36:39], a[24:27], v[120:135]
    ds_read_b64_tr_b16 v[68:69], v20 offset:8992
    ds_read_b64_tr_b16 v[70:71], v20 offset:9888
    s_waitcnt lgkmcnt(10)
    v_mfma_f32_32x32x16_bf16 v[136:151], v[40:43], a[24:27], v[136:151]
    ds_read_b64_tr_b16 v[72:73], v20 offset:9024
    ds_read_b64_tr_b16 v[74:75], v20 offset:9920
    v_mfma_f32_32x32x16_bf16 v[152:167], v[44:47], a[24:27], v[152:167]
    ds_read_b64_tr_b16 v[76:77], v20 offset:9056
    ds_read_b64_tr_b16 v[78:79], v20 offset:9952
    s_waitcnt lgkmcnt(10)
    v_mfma_f32_32x32x16_bf16 v[168:183], v[48:51], a[24:27], v[168:183]
    ds_read_b64_tr_b16 v[80:81], v20 offset:9088
    ds_read_b64_tr_b16 v[82:83], v20 offset:9984
    v_mfma_f32_32x32x16_bf16 v[184:199], v[52:55], a[24:27], v[184:199]
    ds_read_b64_tr_b16 v[84:85], v20 offset:9120
    ds_read_b64_tr_b16 v[86:87], v20 offset:10016
    s_waitcnt lgkmcnt(12)
    v_mfma_f32_32x32x16_bf16 v[200:215], v[56:59], a[24:27], v[200:215]
    ds_read_b64_tr_b16 v[88:89], v20 offset:9152
    ds_read_b64_tr_b16 v[90:91], v20 offset:10048
    s_barrier
    v_add_u32 v21, 0x7100, v20
    s_waitcnt vmcnt(12)
    s_waitcnt lgkmcnt(10)
    v_mfma_f32_32x32x16_bf16 v[104:119], v[64:67], a[28:31], v[104:119]
    ds_read_b64_tr_b16 v[32:33], v21 offset:0
    ds_read_b64_tr_b16 v[34:35], v21 offset:896
    v_mfma_f32_32x32x16_bf16 v[120:135], v[68:71], a[28:31], v[120:135]
    s_add_u32 s62, s53, 0x118000
    s_add_u32 m0, s52, 0x10000
    ds_read_b64_tr_b16 v[36:37], v21 offset:32
    ds_read_b64_tr_b16 v[38:39], v21 offset:928
    buffer_load_dwordx4 v240, s[48:51], s62 offen lds
    s_waitcnt lgkmcnt(10)
    v_mfma_f32_32x32x16_bf16 v[136:151], v[72:75], a[28:31], v[136:151]
    ds_read_b64_tr_b16 v[40:41], v21 offset:64
    ds_read_b64_tr_b16 v[42:43], v21 offset:960
    v_mfma_f32_32x32x16_bf16 v[152:167], v[76:79], a[28:31], v[152:167]
    s_add_u32 m0, s52, 0x10000
    ds_read_b64_tr_b16 v[44:45], v21 offset:96
    ds_read_b64_tr_b16 v[46:47], v21 offset:992
    buffer_load_dwordx4 v241, s[48:51], s62 offen offset:1024 lds
    s_waitcnt lgkmcnt(10)
    v_mfma_f32_32x32x16_bf16 v[168:183], v[80:83], a[28:31], v[168:183]
    ds_read_b64_tr_b16 v[48:49], v21 offset:128
    ds_read_b64_tr_b16 v[50:51], v21 offset:1024
    v_mfma_f32_32x32x16_bf16 v[184:199], v[84:87], a[28:31], v[184:199]
    s_add_u32 m0, s52, 0x10000
    ds_read_b64_tr_b16 v[52:53], v21 offset:160
    ds_read_b64_tr_b16 v[54:55], v21 offset:1056
    buffer_load_dwordx4 v242, s[48:51], s62 offen offset:2048 lds
    s_waitcnt lgkmcnt(12)
    v_mfma_f32_32x32x16_bf16 v[200:215], v[88:91], a[28:31], v[200:215]
    ds_read_b64_tr_b16 v[56:57], v21 offset:192
    ds_read_b64_tr_b16 v[58:59], v21 offset:1088
    v_mov_b32 v20, v21
    s_waitcnt vmcnt(14)
    s_waitcnt lgkmcnt(10)
    v_mfma_f32_32x32x16_bf16 v[104:119], v[32:35], a[32:35], v[104:119]
    ds_read_b64_tr_b16 v[64:65], v20 offset:1792
    ds_read_b64_tr_b16 v[66:67], v20 offset:2688
    v_mfma_f32_32x32x16_bf16 v[120:135], v[36:39], a[32:35], v[120:135]
    s_add_u32 m0, s52, 0x10000
    ds_read_b64_tr_b16 v[68:69], v20 offset:1824
    ds_read_b64_tr_b16 v[70:71], v20 offset:2720
    buffer_load_dwordx4 v243, s[48:51], s62 offen offset:3072 lds
    s_waitcnt lgkmcnt(10)
    v_mfma_f32_32x32x16_bf16 v[136:151], v[40:43], a[32:35], v[136:151]
    ds_read_b64_tr_b16 v[72:73], v20 offset:1856
    ds_read_b64_tr_b16 v[74:75], v20 offset:2752
    v_mfma_f32_32x32x16_bf16 v[152:167], v[44:47], a[32:35], v[152:167]
    s_add_u32 m0, s52, 0x11000
    ds_read_b64_tr_b16 v[76:77], v20 offset:1888
    ds_read_b64_tr_b16 v[78:79], v20 offset:2784
    buffer_load_dwordx4 v244, s[48:51], s62 offen lds
    s_waitcnt lgkmcnt(10)
    v_mfma_f32_32x32x16_bf16 v[168:183], v[48:51], a[32:35], v[168:183]
    ds_read_b64_tr_b16 v[80:81], v20 offset:1920
    ds_read_b64_tr_b16 v[82:83], v20 offset:2816
    v_mfma_f32_32x32x16_bf16 v[184:199], v[52:55], a[32:35], v[184:199]
    s_add_u32 m0, s52, 0x11000
    ds_read_b64_tr_b16 v[84:85], v20 offset:1952
    ds_read_b64_tr_b16 v[86:87], v20 offset:2848
    buffer_load_dwordx4 v245, s[48:51], s62 offen offset:1024 lds
    s_waitcnt lgkmcnt(12)
    v_mfma_f32_32x32x16_bf16 v[200:215], v[56:59], a[32:35], v[200:215]
    ds_read_b64_tr_b16 v[88:89], v20 offset:1984
    ds_read_b64_tr_b16 v[90:91], v20 offset:2880
    s_waitcnt vmcnt(16)
    s_waitcnt lgkmcnt(10)
    v_mfma_f32_32x32x16_bf16 v[104:119], v[64:67], a[36:39], v[104:119]
    ds_read_b64_tr_b16 v[32:33], v20 offset:7168
    ds_read_b64_tr_b16 v[34:35], v20 offset:8064
    v_mfma_f32_32x32x16_bf16 v[120:135], v[68:71], a[36:39], v[120:135]
    s_add_u32 m0, s52, 0x11000
    ds_read_b64_tr_b16 v[36:37], v20 offset:7200
    ds_read_b64_tr_b16 v[38:39], v20 offset:8096
    buffer_load_dwordx4 v246, s[48:51], s62 offen offset:2048 lds
    s_waitcnt lgkmcnt(10)
    v_mfma_f32_32x32x16_bf16 v[136:151], v[72:75], a[36:39], v[136:151]
    ds_read_b64_tr_b16 v[40:41], v20 offset:7232
    ds_read_b64_tr_b16 v[42:43], v20 offset:8128
    v_mfma_f32_32x32x16_bf16 v[152:167], v[76:79], a[36:39], v[152:167]
    ds_read_b64_tr_b16 v[44:45], v20 offset:7264
    ds_read_b64_tr_b16 v[46:47], v20 offset:8160
    s_add_u32 s34, s33, 0x5000
    buffer_load_dwordx4 a[80:83], v2, s[8:11], s34 offen sc1
    s_waitcnt lgkmcnt(10)
    v_mfma_f32_32x32x16_bf16 v[168:183], v[80:83], a[36:39], v[168:183]
    ds_read_b64_tr_b16 v[48:49], v20 offset:7296
    ds_read_b64_tr_b16 v[50:51], v20 offset:8192
    v_mfma_f32_32x32x16_bf16 v[184:199], v[84:87], a[36:39], v[184:199]
    ds_read_b64_tr_b16 v[52:53], v20 offset:7328
    ds_read_b64_tr_b16 v[54:55], v20 offset:8224
    buffer_load_dwordx4 a[84:87], v2, s[8:11], s34 offen offset:1024 sc1
    s_waitcnt lgkmcnt(12)
    v_mfma_f32_32x32x16_bf16 v[200:215], v[88:91], a[36:39], v[200:215]
    ds_read_b64_tr_b16 v[56:57], v20 offset:7360
    ds_read_b64_tr_b16 v[58:59], v20 offset:8256
    s_waitcnt vmcnt(18)
    s_waitcnt lgkmcnt(10)
    v_mfma_f32_32x32x16_bf16 v[104:119], v[32:35], a[40:43], v[104:119]
    ds_read_b64_tr_b16 v[64:65], v20 offset:8960
    ds_read_b64_tr_b16 v[66:67], v20 offset:9856
    v_mfma_f32_32x32x16_bf16 v[120:135], v[36:39], a[40:43], v[120:135]
    ds_read_b64_tr_b16 v[68:69], v20 offset:8992
    ds_read_b64_tr_b16 v[70:71], v20 offset:9888
    buffer_load_dwordx4 a[88:91], v2, s[8:11], s34 offen offset:2048 sc1
    s_waitcnt lgkmcnt(10)
    v_mfma_f32_32x32x16_bf16 v[136:151], v[40:43], a[40:43], v[136:151]
    ds_read_b64_tr_b16 v[72:73], v20 offset:9024
    ds_read_b64_tr_b16 v[74:75], v20 offset:9920
    v_mfma_f32_32x32x16_bf16 v[152:167], v[44:47], a[40:43], v[152:167]
    ds_read_b64_tr_b16 v[76:77], v20 offset:9056
    ds_read_b64_tr_b16 v[78:79], v20 offset:9952
    buffer_load_dwordx4 a[92:95], v2, s[8:11], s34 offen offset:3072 sc1
    s_waitcnt lgkmcnt(10)
    v_mfma_f32_32x32x16_bf16 v[168:183], v[48:51], a[40:43], v[168:183]
    ds_read_b64_tr_b16 v[80:81], v20 offset:9088
    ds_read_b64_tr_b16 v[82:83], v20 offset:9984
    v_mfma_f32_32x32x16_bf16 v[184:199], v[52:55], a[40:43], v[184:199]
    ds_read_b64_tr_b16 v[84:85], v20 offset:9120
    ds_read_b64_tr_b16 v[86:87], v20 offset:10016
    s_waitcnt lgkmcnt(12)
    v_mfma_f32_32x32x16_bf16 v[200:215], v[56:59], a[40:43], v[200:215]
    ds_read_b64_tr_b16 v[88:89], v20 offset:9152
    ds_read_b64_tr_b16 v[90:91], v20 offset:10048
    s_barrier
    v_add_u32 v21, 0xfffe1e00, v20
    s_waitcnt vmcnt(19)
    s_waitcnt lgkmcnt(10)
    v_mfma_f32_32x32x16_bf16 v[104:119], v[64:67], a[44:47], v[104:119]
    ds_read_b64_tr_b16 v[32:33], v21 offset:0
    ds_read_b64_tr_b16 v[34:35], v21 offset:896
    v_mfma_f32_32x32x16_bf16 v[120:135], v[68:71], a[44:47], v[120:135]
    s_add_u32 s62, s53, 0x150000
    s_add_u32 m0, s52, 0x17100
    ds_read_b64_tr_b16 v[36:37], v21 offset:32
    ds_read_b64_tr_b16 v[38:39], v21 offset:928
    buffer_load_dwordx4 v240, s[48:51], s62 offen lds
    s_waitcnt lgkmcnt(10)
    v_mfma_f32_32x32x16_bf16 v[136:151], v[72:75], a[44:47], v[136:151]
    ds_read_b64_tr_b16 v[40:41], v21 offset:64
    ds_read_b64_tr_b16 v[42:43], v21 offset:960
    v_mfma_f32_32x32x16_bf16 v[152:167], v[76:79], a[44:47], v[152:167]
    s_add_u32 m0, s52, 0x17100
    ds_read_b64_tr_b16 v[44:45], v21 offset:96
    ds_read_b64_tr_b16 v[46:47], v21 offset:992
    buffer_load_dwordx4 v241, s[48:51], s62 offen offset:1024 lds
    s_waitcnt lgkmcnt(10)
    v_mfma_f32_32x32x16_bf16 v[168:183], v[80:83], a[44:47], v[168:183]
    ds_read_b64_tr_b16 v[48:49], v21 offset:128
    ds_read_b64_tr_b16 v[50:51], v21 offset:1024
    v_mfma_f32_32x32x16_bf16 v[184:199], v[84:87], a[44:47], v[184:199]
    s_add_u32 m0, s52, 0x17100
    ds_read_b64_tr_b16 v[52:53], v21 offset:160
    ds_read_b64_tr_b16 v[54:55], v21 offset:1056
    buffer_load_dwordx4 v242, s[48:51], s62 offen offset:2048 lds
    s_waitcnt lgkmcnt(12)
    v_mfma_f32_32x32x16_bf16 v[200:215], v[88:91], a[44:47], v[200:215]
    ds_read_b64_tr_b16 v[56:57], v21 offset:192
    ds_read_b64_tr_b16 v[58:59], v21 offset:1088
    v_mov_b32 v20, v21
    s_waitcnt vmcnt(21)
    s_waitcnt lgkmcnt(10)
    v_mfma_f32_32x32x16_bf16 v[104:119], v[32:35], a[48:51], v[104:119]
    ds_read_b64_tr_b16 v[64:65], v20 offset:1792
    ds_read_b64_tr_b16 v[66:67], v20 offset:2688
    v_mfma_f32_32x32x16_bf16 v[120:135], v[36:39], a[48:51], v[120:135]
    s_add_u32 m0, s52, 0x17100
    ds_read_b64_tr_b16 v[68:69], v20 offset:1824
    ds_read_b64_tr_b16 v[70:71], v20 offset:2720
    buffer_load_dwordx4 v243, s[48:51], s62 offen offset:3072 lds
    s_waitcnt lgkmcnt(10)
    v_mfma_f32_32x32x16_bf16 v[136:151], v[40:43], a[48:51], v[136:151]
    ds_read_b64_tr_b16 v[72:73], v20 offset:1856
    ds_read_b64_tr_b16 v[74:75], v20 offset:2752
    v_mfma_f32_32x32x16_bf16 v[152:167], v[44:47], a[48:51], v[152:167]
    s_add_u32 m0, s52, 0x18100
    ds_read_b64_tr_b16 v[76:77], v20 offset:1888
    ds_read_b64_tr_b16 v[78:79], v20 offset:2784
    buffer_load_dwordx4 v244, s[48:51], s62 offen lds
    s_waitcnt lgkmcnt(10)
    v_mfma_f32_32x32x16_bf16 v[168:183], v[48:51], a[48:51], v[168:183]
    ds_read_b64_tr_b16 v[80:81], v20 offset:1920
    ds_read_b64_tr_b16 v[82:83], v20 offset:2816
    v_mfma_f32_32x32x16_bf16 v[184:199], v[52:55], a[48:51], v[184:199]
    s_add_u32 m0, s52, 0x18100
    ds_read_b64_tr_b16 v[84:85], v20 offset:1952
    ds_read_b64_tr_b16 v[86:87], v20 offset:2848
    buffer_load_dwordx4 v245, s[48:51], s62 offen offset:1024 lds
    s_waitcnt lgkmcnt(12)
    v_mfma_f32_32x32x16_bf16 v[200:215], v[56:59], a[48:51], v[200:215]
    ds_read_b64_tr_b16 v[88:89], v20 offset:1984
    ds_read_b64_tr_b16 v[90:91], v20 offset:2880
    s_waitcnt vmcnt(23)
    s_waitcnt lgkmcnt(10)
    v_mfma_f32_32x32x16_bf16 v[104:119], v[64:67], a[52:55], v[104:119]
    ds_read_b64_tr_b16 v[32:33], v20 offset:7168
    ds_read_b64_tr_b16 v[34:35], v20 offset:8064
    v_mfma_f32_32x32x16_bf16 v[120:135], v[68:71], a[52:55], v[120:135]
    s_add_u32 m0, s52, 0x18100
    ds_read_b64_tr_b16 v[36:37], v20 offset:7200
    ds_read_b64_tr_b16 v[38:39], v20 offset:8096
    buffer_load_dwordx4 v246, s[48:51], s62 offen offset:2048 lds
    s_waitcnt lgkmcnt(10)
    v_mfma_f32_32x32x16_bf16 v[136:151], v[72:75], a[52:55], v[136:151]
    ds_read_b64_tr_b16 v[40:41], v20 offset:7232
    ds_read_b64_tr_b16 v[42:43], v20 offset:8128
    v_mfma_f32_32x32x16_bf16 v[152:167], v[76:79], a[52:55], v[152:167]
    ds_read_b64_tr_b16 v[44:45], v20 offset:7264
    ds_read_b64_tr_b16 v[46:47], v20 offset:8160
    s_add_u32 s34, s33, 0x6000
    buffer_load_dwordx4 a[96:99], v2, s[8:11], s34 offen sc1
    s_waitcnt lgkmcnt(10)
    v_mfma_f32_32x32x16_bf16 v[168:183], v[80:83], a[52:55], v[168:183]
    ds_read_b64_tr_b16 v[48:49], v20 offset:7296
    ds_read_b64_tr_b16 v[50:51], v20 offset:8192
    v_mfma_f32_32x32x16_bf16 v[184:199], v[84:87], a[52:55], v[184:199]
    ds_read_b64_tr_b16 v[52:53], v20 offset:7328
    ds_read_b64_tr_b16 v[54:55], v20 offset:8224
    buffer_load_dwordx4 a[100:103], v2, s[8:11], s34 offen offset:1024 sc1
    s_waitcnt lgkmcnt(12)
    v_mfma_f32_32x32x16_bf16 v[200:215], v[88:91], a[52:55], v[200:215]
    ds_read_b64_tr_b16 v[56:57], v20 offset:7360
    ds_read_b64_tr_b16 v[58:59], v20 offset:8256
    s_waitcnt vmcnt(25)
    s_waitcnt lgkmcnt(10)
    v_mfma_f32_32x32x16_bf16 v[104:119], v[32:35], a[56:59], v[104:119]
    ds_read_b64_tr_b16 v[64:65], v20 offset:8960
    ds_read_b64_tr_b16 v[66:67], v20 offset:9856
    v_mfma_f32_32x32x16_bf16 v[120:135], v[36:39], a[56:59], v[120:135]
    ds_read_b64_tr_b16 v[68:69], v20 offset:8992
    ds_read_b64_tr_b16 v[70:71], v20 offset:9888
    buffer_load_dwordx4 a[104:107], v2, s[8:11], s34 offen offset:2048 sc1
    s_waitcnt lgkmcnt(10)
    v_mfma_f32_32x32x16_bf16 v[136:151], v[40:43], a[56:59], v[136:151]
    ds_read_b64_tr_b16 v[72:73], v20 offset:9024
    ds_read_b64_tr_b16 v[74:75], v20 offset:9920
    v_mfma_f32_32x32x16_bf16 v[152:167], v[44:47], a[56:59], v[152:167]
    ds_read_b64_tr_b16 v[76:77], v20 offset:9056
    ds_read_b64_tr_b16 v[78:79], v20 offset:9952
    buffer_load_dwordx4 a[108:111], v2, s[8:11], s34 offen offset:3072 sc1
    s_waitcnt lgkmcnt(10)
    v_mfma_f32_32x32x16_bf16 v[168:183], v[48:51], a[56:59], v[168:183]
    ds_read_b64_tr_b16 v[80:81], v20 offset:9088
    ds_read_b64_tr_b16 v[82:83], v20 offset:9984
    v_mfma_f32_32x32x16_bf16 v[184:199], v[52:55], a[56:59], v[184:199]
    ds_read_b64_tr_b16 v[84:85], v20 offset:9120
    ds_read_b64_tr_b16 v[86:87], v20 offset:10016
    s_waitcnt lgkmcnt(12)
    v_mfma_f32_32x32x16_bf16 v[200:215], v[56:59], a[56:59], v[200:215]
    ds_read_b64_tr_b16 v[88:89], v20 offset:9152
    ds_read_b64_tr_b16 v[90:91], v20 offset:10048
    s_barrier
    v_add_u32 v21, 0x7100, v20
    s_waitcnt vmcnt(26)
    s_waitcnt lgkmcnt(10)
    v_mfma_f32_32x32x16_bf16 v[104:119], v[64:67], a[60:63], v[104:119]
    ds_read_b64_tr_b16 v[32:33], v21 offset:0
    ds_read_b64_tr_b16 v[34:35], v21 offset:896
    v_mfma_f32_32x32x16_bf16 v[120:135], v[68:71], a[60:63], v[120:135]
    s_add_u32 s62, s53, 0x188000
    s_add_u32 m0, s52, 0x1e200
    ds_read_b64_tr_b16 v[36:37], v21 offset:32
    ds_read_b64_tr_b16 v[38:39], v21 offset:928
    buffer_load_dwordx4 v240, s[48:51], s62 offen lds
    s_waitcnt lgkmcnt(10)
    v_mfma_f32_32x32x16_bf16 v[136:151], v[72:75], a[60:63], v[136:151]
    ds_read_b64_tr_b16 v[40:41], v21 offset:64
    ds_read_b64_tr_b16 v[42:43], v21 offset:960
    v_mfma_f32_32x32x16_bf16 v[152:167], v[76:79], a[60:63], v[152:167]
    s_add_u32 m0, s52, 0x1e200
    ds_read_b64_tr_b16 v[44:45], v21 offset:96
    ds_read_b64_tr_b16 v[46:47], v21 offset:992
    buffer_load_dwordx4 v241, s[48:51], s62 offen offset:1024 lds
    s_waitcnt lgkmcnt(10)
    v_mfma_f32_32x32x16_bf16 v[168:183], v[80:83], a[60:63], v[168:183]
    ds_read_b64_tr_b16 v[48:49], v21 offset:128
    ds_read_b64_tr_b16 v[50:51], v21 offset:1024
    v_mfma_f32_32x32x16_bf16 v[184:199], v[84:87], a[60:63], v[184:199]
    s_add_u32 m0, s52, 0x1e200
    ds_read_b64_tr_b16 v[52:53], v21 offset:160
    ds_read_b64_tr_b16 v[54:55], v21 offset:1056
    buffer_load_dwordx4 v242, s[48:51], s62 offen offset:2048 lds
    s_waitcnt lgkmcnt(12)
    v_mfma_f32_32x32x16_bf16 v[200:215], v[88:91], a[60:63], v[200:215]
    ds_read_b64_tr_b16 v[56:57], v21 offset:192
    ds_read_b64_tr_b16 v[58:59], v21 offset:1088
    v_mov_b32 v20, v21
    s_waitcnt vmcnt(28)
    s_waitcnt lgkmcnt(10)
    v_mfma_f32_32x32x16_bf16 v[104:119], v[32:35], a[64:67], v[104:119]
    ds_read_b64_tr_b16 v[64:65], v20 offset:1792
    ds_read_b64_tr_b16 v[66:67], v20 offset:2688
    v_mfma_f32_32x32x16_bf16 v[120:135], v[36:39], a[64:67], v[120:135]
    s_add_u32 m0, s52, 0x1e200
    ds_read_b64_tr_b16 v[68:69], v20 offset:1824
    ds_read_b64_tr_b16 v[70:71], v20 offset:2720
    buffer_load_dwordx4 v243, s[48:51], s62 offen offset:3072 lds
    s_waitcnt lgkmcnt(10)
    v_mfma_f32_32x32x16_bf16 v[136:151], v[40:43], a[64:67], v[136:151]
    ds_read_b64_tr_b16 v[72:73], v20 offset:1856
    ds_read_b64_tr_b16 v[74:75], v20 offset:2752
    v_mfma_f32_32x32x16_bf16 v[152:167], v[44:47], a[64:67], v[152:167]
    s_add_u32 m0, s52, 0x1f200
    ds_read_b64_tr_b16 v[76:77], v20 offset:1888
    ds_read_b64_tr_b16 v[78:79], v20 offset:2784
    buffer_load_dwordx4 v244, s[48:51], s62 offen lds
    s_waitcnt lgkmcnt(10)
    v_mfma_f32_32x32x16_bf16 v[168:183], v[48:51], a[64:67], v[168:183]
    ds_read_b64_tr_b16 v[80:81], v20 offset:1920
    ds_read_b64_tr_b16 v[82:83], v20 offset:2816
    v_mfma_f32_32x32x16_bf16 v[184:199], v[52:55], a[64:67], v[184:199]
    s_add_u32 m0, s52, 0x1f200
    ds_read_b64_tr_b16 v[84:85], v20 offset:1952
    ds_read_b64_tr_b16 v[86:87], v20 offset:2848
    buffer_load_dwordx4 v245, s[48:51], s62 offen offset:1024 lds
    s_waitcnt lgkmcnt(12)
    v_mfma_f32_32x32x16_bf16 v[200:215], v[56:59], a[64:67], v[200:215]
    ds_read_b64_tr_b16 v[88:89], v20 offset:1984
    ds_read_b64_tr_b16 v[90:91], v20 offset:2880
    s_waitcnt vmcnt(30)
    s_waitcnt lgkmcnt(10)
    v_mfma_f32_32x32x16_bf16 v[104:119], v[64:67], a[68:71], v[104:119]
    ds_read_b64_tr_b16 v[32:33], v20 offset:7168
    ds_read_b64_tr_b16 v[34:35], v20 offset:8064
    v_mfma_f32_32x32x16_bf16 v[120:135], v[68:71], a[68:71], v[120:135]
    s_add_u32 m0, s52, 0x1f200
    ds_read_b64_tr_b16 v[36:37], v20 offset:7200
    ds_read_b64_tr_b16 v[38:39], v20 offset:8096
    buffer_load_dwordx4 v246, s[48:51], s62 offen offset:2048 lds
    s_waitcnt lgkmcnt(10)
    v_mfma_f32_32x32x16_bf16 v[136:151], v[72:75], a[68:71], v[136:151]
    ds_read_b64_tr_b16 v[40:41], v20 offset:7232
    ds_read_b64_tr_b16 v[42:43], v20 offset:8128
    v_mfma_f32_32x32x16_bf16 v[152:167], v[76:79], a[68:71], v[152:167]
    ds_read_b64_tr_b16 v[44:45], v20 offset:7264
    ds_read_b64_tr_b16 v[46:47], v20 offset:8160
    s_add_u32 s34, s33, 0x7000
    buffer_load_dwordx4 a[112:115], v2, s[8:11], s34 offen sc1
    s_waitcnt lgkmcnt(10)
    v_mfma_f32_32x32x16_bf16 v[168:183], v[80:83], a[68:71], v[168:183]
    ds_read_b64_tr_b16 v[48:49], v20 offset:7296
    ds_read_b64_tr_b16 v[50:51], v20 offset:8192
    v_mfma_f32_32x32x16_bf16 v[184:199], v[84:87], a[68:71], v[184:199]
    ds_read_b64_tr_b16 v[52:53], v20 offset:7328
    ds_read_b64_tr_b16 v[54:55], v20 offset:8224
    buffer_load_dwordx4 a[116:119], v2, s[8:11], s34 offen offset:1024 sc1
    s_waitcnt lgkmcnt(12)
    v_mfma_f32_32x32x16_bf16 v[200:215], v[88:91], a[68:71], v[200:215]
    ds_read_b64_tr_b16 v[56:57], v20 offset:7360
    ds_read_b64_tr_b16 v[58:59], v20 offset:8256
    s_waitcnt vmcnt(32)
    s_waitcnt lgkmcnt(10)
    v_mfma_f32_32x32x16_bf16 v[104:119], v[32:35], a[72:75], v[104:119]
    ds_read_b64_tr_b16 v[64:65], v20 offset:8960
    ds_read_b64_tr_b16 v[66:67], v20 offset:9856
    v_mfma_f32_32x32x16_bf16 v[120:135], v[36:39], a[72:75], v[120:135]
    ds_read_b64_tr_b16 v[68:69], v20 offset:8992
    ds_read_b64_tr_b16 v[70:71], v20 offset:9888
    buffer_load_dwordx4 a[120:123], v2, s[8:11], s34 offen offset:2048 sc1
    s_waitcnt lgkmcnt(10)
    v_mfma_f32_32x32x16_bf16 v[136:151], v[40:43], a[72:75], v[136:151]
    ds_read_b64_tr_b16 v[72:73], v20 offset:9024
    ds_read_b64_tr_b16 v[74:75], v20 offset:9920
    v_mfma_f32_32x32x16_bf16 v[152:167], v[44:47], a[72:75], v[152:167]
    ds_read_b64_tr_b16 v[76:77], v20 offset:9056
    ds_read_b64_tr_b16 v[78:79], v20 offset:9952
    buffer_load_dwordx4 a[124:127], v2, s[8:11], s34 offen offset:3072 sc1
    s_waitcnt lgkmcnt(10)
    v_mfma_f32_32x32x16_bf16 v[168:183], v[48:51], a[72:75], v[168:183]
    ds_read_b64_tr_b16 v[80:81], v20 offset:9088
    ds_read_b64_tr_b16 v[82:83], v20 offset:9984
    v_mfma_f32_32x32x16_bf16 v[184:199], v[52:55], a[72:75], v[184:199]
    ds_read_b64_tr_b16 v[84:85], v20 offset:9120
    ds_read_b64_tr_b16 v[86:87], v20 offset:10016
    s_waitcnt lgkmcnt(12)
    v_mfma_f32_32x32x16_bf16 v[200:215], v[56:59], a[72:75], v[200:215]
    ds_read_b64_tr_b16 v[88:89], v20 offset:9152
    ds_read_b64_tr_b16 v[90:91], v20 offset:10048
    s_waitcnt vmcnt(26)
    s_barrier
    v_add_u32 v21, 0x8f00, v20
    s_waitcnt lgkmcnt(10)
    v_mfma_f32_32x32x16_bf16 v[104:119], v[64:67], a[76:79], v[104:119]
    ds_read_b64_tr_b16 v[32:33], v21 offset:0
    ds_read_b64_tr_b16 v[34:35], v21 offset:896
    v_mfma_f32_32x32x16_bf16 v[120:135], v[68:71], a[76:79], v[120:135]
    s_add_u32 s63, s58, 0
    s_add_u32 m0, s59, 0
    ds_read_b64_tr_b16 v[36:37], v21 offset:32
    ds_read_b64_tr_b16 v[38:39], v21 offset:928
    buffer_load_dwordx4 v248, s[28:31], s63 offen lds
    s_waitcnt lgkmcnt(10)
    v_mfma_f32_32x32x16_bf16 v[136:151], v[72:75], a[76:79], v[136:151]
    ds_read_b64_tr_b16 v[40:41], v21 offset:64
    ds_read_b64_tr_b16 v[42:43], v21 offset:960
    v_mfma_f32_32x32x16_bf16 v[152:167], v[76:79], a[76:79], v[152:167]
    s_add_u32 m0, s59, 0
    ds_read_b64_tr_b16 v[44:45], v21 offset:96
    ds_read_b64_tr_b16 v[46:47], v21 offset:992
    buffer_load_dwordx4 v249, s[28:31], s63 offen offset:1024 lds
    s_waitcnt lgkmcnt(10)
    v_mfma_f32_32x32x16_bf16 v[168:183], v[80:83], a[76:79], v[168:183]
    ds_read_b64_tr_b16 v[48:49], v21 offset:128
    ds_read_b64_tr_b16 v[50:51], v21 offset:1024
    v_mfma_f32_32x32x16_bf16 v[184:199], v[84:87], a[76:79], v[184:199]
    s_add_u32 s63, s58, 0x4000
    s_add_u32 m0, s59, 0x2000
    ds_read_b64_tr_b16 v[52:53], v21 offset:160
    ds_read_b64_tr_b16 v[54:55], v21 offset:1056
    buffer_load_dwordx4 v248, s[28:31], s63 offen lds
    s_waitcnt lgkmcnt(12)
    v_mfma_f32_32x32x16_bf16 v[200:215], v[88:91], a[76:79], v[200:215]
    ds_read_b64_tr_b16 v[56:57], v21 offset:192
    ds_read_b64_tr_b16 v[58:59], v21 offset:1088
    v_mov_b32 v20, v21
    s_waitcnt vmcnt(28)
    s_waitcnt lgkmcnt(10)
    v_mfma_f32_32x32x16_bf16 v[104:119], v[32:35], a[80:83], v[104:119]
    ds_read_b64_tr_b16 v[64:65], v20 offset:1792
    ds_read_b64_tr_b16 v[66:67], v20 offset:2688
    v_mfma_f32_32x32x16_bf16 v[120:135], v[36:39], a[80:83], v[120:135]
    s_add_u32 m0, s59, 0x2000
    ds_read_b64_tr_b16 v[68:69], v20 offset:1824
    ds_read_b64_tr_b16 v[70:71], v20 offset:2720
    buffer_load_dwordx4 v249, s[28:31], s63 offen offset:1024 lds
    s_waitcnt lgkmcnt(10)
    v_mfma_f32_32x32x16_bf16 v[136:151], v[40:43], a[80:83], v[136:151]
    ds_read_b64_tr_b16 v[72:73], v20 offset:1856
    ds_read_b64_tr_b16 v[74:75], v20 offset:2752
    v_mfma_f32_32x32x16_bf16 v[152:167], v[44:47], a[80:83], v[152:167]
    s_add_u32 s63, s58, 0x8000
    s_add_u32 m0, s59, 0x4000
    ds_read_b64_tr_b16 v[76:77], v20 offset:1888
    ds_read_b64_tr_b16 v[78:79], v20 offset:2784
    buffer_load_dwordx4 v248, s[28:31], s63 offen lds
    s_waitcnt lgkmcnt(10)
    v_mfma_f32_32x32x16_bf16 v[168:183], v[48:51], a[80:83], v[168:183]
    ds_read_b64_tr_b16 v[80:81], v20 offset:1920
    ds_read_b64_tr_b16 v[82:83], v20 offset:2816
    v_mfma_f32_32x32x16_bf16 v[184:199], v[52:55], a[80:83], v[184:199]
    s_add_u32 m0, s59, 0x4000
    ds_read_b64_tr_b16 v[84:85], v20 offset:1952
    ds_read_b64_tr_b16 v[86:87], v20 offset:2848
    buffer_load_dwordx4 v249, s[28:31], s63 offen offset:1024 lds
    s_waitcnt lgkmcnt(12)
    v_mfma_f32_32x32x16_bf16 v[200:215], v[56:59], a[80:83], v[200:215]
    ds_read_b64_tr_b16 v[88:89], v20 offset:1984
    ds_read_b64_tr_b16 v[90:91], v20 offset:2880
    s_waitcnt vmcnt(30)
    s_waitcnt lgkmcnt(10)
    v_mfma_f32_32x32x16_bf16 v[104:119], v[64:67], a[84:87], v[104:119]
    ds_read_b64_tr_b16 v[32:33], v20 offset:7168
    ds_read_b64_tr_b16 v[34:35], v20 offset:8064
    v_mfma_f32_32x32x16_bf16 v[120:135], v[68:71], a[84:87], v[120:135]
    ds_read_b64_tr_b16 v[36:37], v20 offset:7200
    ds_read_b64_tr_b16 v[38:39], v20 offset:8096
    s_waitcnt lgkmcnt(10)
    v_mfma_f32_32x32x16_bf16 v[136:151], v[72:75], a[84:87], v[136:151]
    ds_read_b64_tr_b16 v[40:41], v20 offset:7232
    ds_read_b64_tr_b16 v[42:43], v20 offset:8128
    v_mfma_f32_32x32x16_bf16 v[152:167], v[76:79], a[84:87], v[152:167]
    ds_read_b64_tr_b16 v[44:45], v20 offset:7264
    ds_read_b64_tr_b16 v[46:47], v20 offset:8160
    s_waitcnt lgkmcnt(10)
    v_mfma_f32_32x32x16_bf16 v[168:183], v[80:83], a[84:87], v[168:183]
    ds_read_b64_tr_b16 v[48:49], v20 offset:7296
    ds_read_b64_tr_b16 v[50:51], v20 offset:8192
    v_mfma_f32_32x32x16_bf16 v[184:199], v[84:87], a[84:87], v[184:199]
    ds_read_b64_tr_b16 v[52:53], v20 offset:7328
    ds_read_b64_tr_b16 v[54:55], v20 offset:8224
    s_waitcnt lgkmcnt(12)
    v_mfma_f32_32x32x16_bf16 v[200:215], v[88:91], a[84:87], v[200:215]
    ds_read_b64_tr_b16 v[56:57], v20 offset:7360
    ds_read_b64_tr_b16 v[58:59], v20 offset:8256
    s_waitcnt vmcnt(29)
    s_waitcnt lgkmcnt(10)
    v_mfma_f32_32x32x16_bf16 v[104:119], v[32:35], a[88:91], v[104:119]
    ds_read_b64_tr_b16 v[64:65], v20 offset:8960
    ds_read_b64_tr_b16 v[66:67], v20 offset:9856
    v_mfma_f32_32x32x16_bf16 v[120:135], v[36:39], a[88:91], v[120:135]
    ds_read_b64_tr_b16 v[68:69], v20 offset:8992
    ds_read_b64_tr_b16 v[70:71], v20 offset:9888
    s_waitcnt lgkmcnt(10)
    v_mfma_f32_32x32x16_bf16 v[136:151], v[40:43], a[88:91], v[136:151]
    ds_read_b64_tr_b16 v[72:73], v20 offset:9024
    ds_read_b64_tr_b16 v[74:75], v20 offset:9920
    v_mfma_f32_32x32x16_bf16 v[152:167], v[44:47], a[88:91], v[152:167]
    ds_read_b64_tr_b16 v[76:77], v20 offset:9056
    ds_read_b64_tr_b16 v[78:79], v20 offset:9952
    s_waitcnt lgkmcnt(10)
    v_mfma_f32_32x32x16_bf16 v[168:183], v[48:51], a[88:91], v[168:183]
    ds_read_b64_tr_b16 v[80:81], v20 offset:9088
    ds_read_b64_tr_b16 v[82:83], v20 offset:9984
    v_mfma_f32_32x32x16_bf16 v[184:199], v[52:55], a[88:91], v[184:199]
    ds_read_b64_tr_b16 v[84:85], v20 offset:9120
    ds_read_b64_tr_b16 v[86:87], v20 offset:10016
    s_waitcnt lgkmcnt(12)
    v_mfma_f32_32x32x16_bf16 v[200:215], v[56:59], a[88:91], v[200:215]
    ds_read_b64_tr_b16 v[88:89], v20 offset:9152
    ds_read_b64_tr_b16 v[90:91], v20 offset:10048
    s_waitcnt vmcnt(21)
    s_barrier
    v_add_u32 v21, 0x7100, v20
    s_waitcnt lgkmcnt(10)
    v_mfma_f32_32x32x16_bf16 v[104:119], v[64:67], a[92:95], v[104:119]
    ds_read_b64_tr_b16 v[32:33], v21 offset:0
    ds_read_b64_tr_b16 v[34:35], v21 offset:896
    v_mfma_f32_32x32x16_bf16 v[120:135], v[68:71], a[92:95], v[120:135]
    s_add_u32 s63, s58, 0xc000
    s_add_u32 m0, s59, 0x6000
    ds_read_b64_tr_b16 v[36:37], v21 offset:32
    ds_read_b64_tr_b16 v[38:39], v21 offset:928
    buffer_load_dwordx4 v248, s[28:31], s63 offen lds
    s_waitcnt lgkmcnt(10)
    v_mfma_f32_32x32x16_bf16 v[136:151], v[72:75], a[92:95], v[136:151]
    ds_read_b64_tr_b16 v[40:41], v21 offset:64
    ds_read_b64_tr_b16 v[42:43], v21 offset:960
    v_mfma_f32_32x32x16_bf16 v[152:167], v[76:79], a[92:95], v[152:167]
    s_add_u32 m0, s59, 0x6000
    ds_read_b64_tr_b16 v[44:45], v21 offset:96
    ds_read_b64_tr_b16 v[46:47], v21 offset:992
    buffer_load_dwordx4 v249, s[28:31], s63 offen offset:1024 lds
    s_waitcnt lgkmcnt(10)
    v_mfma_f32_32x32x16_bf16 v[168:183], v[80:83], a[92:95], v[168:183]
    ds_read_b64_tr_b16 v[48:49], v21 offset:128
    ds_read_b64_tr_b16 v[50:51], v21 offset:1024
    v_mfma_f32_32x32x16_bf16 v[184:199], v[84:87], a[92:95], v[184:199]
    s_add_u32 s63, s58, 0x10000
    s_add_u32 m0, s59, 0x8000
    ds_read_b64_tr_b16 v[52:53], v21 offset:160
    ds_read_b64_tr_b16 v[54:55], v21 offset:1056
    buffer_load_dwordx4 v248, s[28:31], s63 offen lds
    s_waitcnt lgkmcnt(12)
    v_mfma_f32_32x32x16_bf16 v[200:215], v[88:91], a[92:95], v[200:215]
    ds_read_b64_tr_b16 v[56:57], v21 offset:192
    ds_read_b64_tr_b16 v[58:59], v21 offset:1088
    v_mov_b32 v20, v21
    s_waitcnt vmcnt(23)
    s_waitcnt lgkmcnt(10)
    v_mfma_f32_32x32x16_bf16 v[104:119], v[32:35], a[96:99], v[104:119]
    ds_read_b64_tr_b16 v[64:65], v20 offset:1792
    ds_read_b64_tr_b16 v[66:67], v20 offset:2688
    v_mfma_f32_32x32x16_bf16 v[120:135], v[36:39], a[96:99], v[120:135]
    s_add_u32 m0, s59, 0x8000
    ds_read_b64_tr_b16 v[68:69], v20 offset:1824
    ds_read_b64_tr_b16 v[70:71], v20 offset:2720
    buffer_load_dwordx4 v249, s[28:31], s63 offen offset:1024 lds
    s_waitcnt lgkmcnt(10)
    v_mfma_f32_32x32x16_bf16 v[136:151], v[40:43], a[96:99], v[136:151]
    ds_read_b64_tr_b16 v[72:73], v20 offset:1856
    ds_read_b64_tr_b16 v[74:75], v20 offset:2752
    v_mfma_f32_32x32x16_bf16 v[152:167], v[44:47], a[96:99], v[152:167]
    s_add_u32 s63, s58, 0x14000
    s_add_u32 m0, s59, 0xa000
    ds_read_b64_tr_b16 v[76:77], v20 offset:1888
    ds_read_b64_tr_b16 v[78:79], v20 offset:2784
    buffer_load_dwordx4 v248, s[28:31], s63 offen lds
    s_waitcnt lgkmcnt(10)
    v_mfma_f32_32x32x16_bf16 v[168:183], v[48:51], a[96:99], v[168:183]
    ds_read_b64_tr_b16 v[80:81], v20 offset:1920
    ds_read_b64_tr_b16 v[82:83], v20 offset:2816
    v_mfma_f32_32x32x16_bf16 v[184:199], v[52:55], a[96:99], v[184:199]
    s_add_u32 m0, s59, 0xa000
    ds_read_b64_tr_b16 v[84:85], v20 offset:1952
    ds_read_b64_tr_b16 v[86:87], v20 offset:2848
    buffer_load_dwordx4 v249, s[28:31], s63 offen offset:1024 lds
    s_waitcnt lgkmcnt(12)
    v_mfma_f32_32x32x16_bf16 v[200:215], v[56:59], a[96:99], v[200:215]
    ds_read_b64_tr_b16 v[88:89], v20 offset:1984
    ds_read_b64_tr_b16 v[90:91], v20 offset:2880
    s_waitcnt vmcnt(25)
    s_waitcnt lgkmcnt(10)
    v_mfma_f32_32x32x16_bf16 v[104:119], v[64:67], a[100:103], v[104:119]
    ds_read_b64_tr_b16 v[32:33], v20 offset:7168
    ds_read_b64_tr_b16 v[34:35], v20 offset:8064
    v_mfma_f32_32x32x16_bf16 v[120:135], v[68:71], a[100:103], v[120:135]
    s_add_u32 s63, s58, 0x18000
    s_add_u32 m0, s59, 0xc000
    ds_read_b64_tr_b16 v[36:37], v20 offset:7200
    ds_read_b64_tr_b16 v[38:39], v20 offset:8096
    buffer_load_dwordx4 v248, s[28:31], s63 offen lds
    s_waitcnt lgkmcnt(10)
    v_mfma_f32_32x32x16_bf16 v[136:151], v[72:75], a[100:103], v[136:151]
    ds_read_b64_tr_b16 v[40:41], v20 offset:7232
    ds_read_b64_tr_b16 v[42:43], v20 offset:8128
    v_mfma_f32_32x32x16_bf16 v[152:167], v[76:79], a[100:103], v[152:167]
    s_add_u32 m0, s59, 0xc000
    ds_read_b64_tr_b16 v[44:45], v20 offset:7264
    ds_read_b64_tr_b16 v[46:47], v20 offset:8160
    buffer_load_dwordx4 v249, s[28:31], s63 offen offset:1024 lds
    s_waitcnt lgkmcnt(10)
    v_mfma_f32_32x32x16_bf16 v[168:183], v[80:83], a[100:103], v[168:183]
    ds_read_b64_tr_b16 v[48:49], v20 offset:7296
    ds_read_b64_tr_b16 v[50:51], v20 offset:8192
    v_mfma_f32_32x32x16_bf16 v[184:199], v[84:87], a[100:103], v[184:199]
    s_add_u32 s63, s58, 0x1c000
    s_add_u32 m0, s59, 0xe000
    ds_read_b64_tr_b16 v[52:53], v20 offset:7328
    ds_read_b64_tr_b16 v[54:55], v20 offset:8224
    buffer_load_dwordx4 v248, s[28:31], s63 offen lds
    s_waitcnt lgkmcnt(12)
    v_mfma_f32_32x32x16_bf16 v[200:215], v[88:91], a[100:103], v[200:215]
    ds_read_b64_tr_b16 v[56:57], v20 offset:7360
    ds_read_b64_tr_b16 v[58:59], v20 offset:8256
    s_waitcnt vmcnt(27)
    s_waitcnt lgkmcnt(10)
    v_mfma_f32_32x32x16_bf16 v[104:119], v[32:35], a[104:107], v[104:119]
    ds_read_b64_tr_b16 v[64:65], v20 offset:8960
    ds_read_b64_tr_b16 v[66:67], v20 offset:9856
    v_mfma_f32_32x32x16_bf16 v[120:135], v[36:39], a[104:107], v[120:135]
    s_add_u32 m0, s59, 0xe000
    ds_read_b64_tr_b16 v[68:69], v20 offset:8992
    ds_read_b64_tr_b16 v[70:71], v20 offset:9888
    buffer_load_dwordx4 v249, s[28:31], s63 offen offset:1024 lds
    s_waitcnt lgkmcnt(10)
    v_mfma_f32_32x32x16_bf16 v[136:151], v[40:43], a[104:107], v[136:151]
    ds_read_b64_tr_b16 v[72:73], v20 offset:9024
    ds_read_b64_tr_b16 v[74:75], v20 offset:9920
    v_mfma_f32_32x32x16_bf16 v[152:167], v[44:47], a[104:107], v[152:167]
    ds_read_b64_tr_b16 v[76:77], v20 offset:9056
    ds_read_b64_tr_b16 v[78:79], v20 offset:9952
    s_waitcnt lgkmcnt(10)
    v_mfma_f32_32x32x16_bf16 v[168:183], v[48:51], a[104:107], v[168:183]
    ds_read_b64_tr_b16 v[80:81], v20 offset:9088
    ds_read_b64_tr_b16 v[82:83], v20 offset:9984
    v_mfma_f32_32x32x16_bf16 v[184:199], v[52:55], a[104:107], v[184:199]
    ds_read_b64_tr_b16 v[84:85], v20 offset:9120
    ds_read_b64_tr_b16 v[86:87], v20 offset:10016
    s_waitcnt lgkmcnt(12)
    v_mfma_f32_32x32x16_bf16 v[200:215], v[56:59], a[104:107], v[200:215]
    ds_read_b64_tr_b16 v[88:89], v20 offset:9152
    ds_read_b64_tr_b16 v[90:91], v20 offset:10048
    s_waitcnt vmcnt(20)
    s_barrier
    v_add_u32 v21, 0x7100, v20
    s_waitcnt lgkmcnt(10)
    v_mfma_f32_32x32x16_bf16 v[104:119], v[64:67], a[108:111], v[104:119]
    ds_read_b64_tr_b16 v[32:33], v21 offset:0
    ds_read_b64_tr_b16 v[34:35], v21 offset:896
    v_mfma_f32_32x32x16_bf16 v[120:135], v[68:71], a[108:111], v[120:135]
    s_add_u32 s63, s58, 0x20000
    s_add_u32 m0, s59, 0x10000
    ds_read_b64_tr_b16 v[36:37], v21 offset:32
    ds_read_b64_tr_b16 v[38:39], v21 offset:928
    buffer_load_dwordx4 v248, s[28:31], s63 offen lds
    s_waitcnt lgkmcnt(10)
    v_mfma_f32_32x32x16_bf16 v[136:151], v[72:75], a[108:111], v[136:151]
    ds_read_b64_tr_b16 v[40:41], v21 offset:64
    ds_read_b64_tr_b16 v[42:43], v21 offset:960
    v_mfma_f32_32x32x16_bf16 v[152:167], v[76:79], a[108:111], v[152:167]
    s_add_u32 m0, s59, 0x10000
    ds_read_b64_tr_b16 v[44:45], v21 offset:96
    ds_read_b64_tr_b16 v[46:47], v21 offset:992
    buffer_load_dwordx4 v249, s[28:31], s63 offen offset:1024 lds
    s_waitcnt lgkmcnt(10)
    v_mfma_f32_32x32x16_bf16 v[168:183], v[80:83], a[108:111], v[168:183]
    ds_read_b64_tr_b16 v[48:49], v21 offset:128
    ds_read_b64_tr_b16 v[50:51], v21 offset:1024
    v_mfma_f32_32x32x16_bf16 v[184:199], v[84:87], a[108:111], v[184:199]
    s_add_u32 s63, s58, 0x24000
    s_add_u32 m0, s59, 0x12000
    ds_read_b64_tr_b16 v[52:53], v21 offset:160
    ds_read_b64_tr_b16 v[54:55], v21 offset:1056
    buffer_load_dwordx4 v248, s[28:31], s63 offen lds
    s_waitcnt lgkmcnt(12)
    v_mfma_f32_32x32x16_bf16 v[200:215], v[88:91], a[108:111], v[200:215]
    ds_read_b64_tr_b16 v[56:57], v21 offset:192
    ds_read_b64_tr_b16 v[58:59], v21 offset:1088
    v_mov_b32 v20, v21
    s_waitcnt vmcnt(22)
    s_waitcnt lgkmcnt(10)
    v_mfma_f32_32x32x16_bf16 v[104:119], v[32:35], a[112:115], v[104:119]
    ds_read_b64_tr_b16 v[64:65], v20 offset:1792
    ds_read_b64_tr_b16 v[66:67], v20 offset:2688
    v_mfma_f32_32x32x16_bf16 v[120:135], v[36:39], a[112:115], v[120:135]
    s_add_u32 m0, s59, 0x12000
    ds_read_b64_tr_b16 v[68:69], v20 offset:1824
    ds_read_b64_tr_b16 v[70:71], v20 offset:2720
    buffer_load_dwordx4 v249, s[28:31], s63 offen offset:1024 lds
    s_waitcnt lgkmcnt(10)
    v_mfma_f32_32x32x16_bf16 v[136:151], v[40:43], a[112:115], v[136:151]
    ds_read_b64_tr_b16 v[72:73], v20 offset:1856
    ds_read_b64_tr_b16 v[74:75], v20 offset:2752
    v_mfma_f32_32x32x16_bf16 v[152:167], v[44:47], a[112:115], v[152:167]
    s_add_u32 s63, s58, 0x28000
    s_add_u32 m0, s59, 0x14000
    ds_read_b64_tr_b16 v[76:77], v20 offset:1888
    ds_read_b64_tr_b16 v[78:79], v20 offset:2784
    buffer_load_dwordx4 v248, s[28:31], s63 offen lds
    s_waitcnt lgkmcnt(10)
    v_mfma_f32_32x32x16_bf16 v[168:183], v[48:51], a[112:115], v[168:183]
    ds_read_b64_tr_b16 v[80:81], v20 offset:1920
    ds_read_b64_tr_b16 v[82:83], v20 offset:2816
    v_mfma_f32_32x32x16_bf16 v[184:199], v[52:55], a[112:115], v[184:199]
    s_add_u32 m0, s59, 0x14000
    ds_read_b64_tr_b16 v[84:85], v20 offset:1952
    ds_read_b64_tr_b16 v[86:87], v20 offset:2848
    buffer_load_dwordx4 v249, s[28:31], s63 offen offset:1024 lds
    s_waitcnt lgkmcnt(12)
    v_mfma_f32_32x32x16_bf16 v[200:215], v[56:59], a[112:115], v[200:215]
    ds_read_b64_tr_b16 v[88:89], v20 offset:1984
    ds_read_b64_tr_b16 v[90:91], v20 offset:2880
    s_waitcnt vmcnt(24)
    s_waitcnt lgkmcnt(10)
    v_mfma_f32_32x32x16_bf16 v[104:119], v[64:67], a[116:119], v[104:119]
    ds_read_b64_tr_b16 v[32:33], v20 offset:7168
    ds_read_b64_tr_b16 v[34:35], v20 offset:8064
    v_mfma_f32_32x32x16_bf16 v[120:135], v[68:71], a[116:119], v[120:135]
    ds_read_b64_tr_b16 v[36:37], v20 offset:7200
    ds_read_b64_tr_b16 v[38:39], v20 offset:8096
    s_waitcnt lgkmcnt(10)
    v_mfma_f32_32x32x16_bf16 v[136:151], v[72:75], a[116:119], v[136:151]
    ds_read_b64_tr_b16 v[40:41], v20 offset:7232
    ds_read_b64_tr_b16 v[42:43], v20 offset:8128
    v_mfma_f32_32x32x16_bf16 v[152:167], v[76:79], a[116:119], v[152:167]
    ds_read_b64_tr_b16 v[44:45], v20 offset:7264
    ds_read_b64_tr_b16 v[46:47], v20 offset:8160
    s_waitcnt lgkmcnt(10)
    v_mfma_f32_32x32x16_bf16 v[168:183], v[80:83], a[116:119], v[168:183]
    ds_read_b64_tr_b16 v[48:49], v20 offset:7296
    ds_read_b64_tr_b16 v[50:51], v20 offset:8192
    v_mfma_f32_32x32x16_bf16 v[184:199], v[84:87], a[116:119], v[184:199]
    ds_read_b64_tr_b16 v[52:53], v20 offset:7328
    ds_read_b64_tr_b16 v[54:55], v20 offset:8224
    s_waitcnt lgkmcnt(12)
    v_mfma_f32_32x32x16_bf16 v[200:215], v[88:91], a[116:119], v[200:215]
    ds_read_b64_tr_b16 v[56:57], v20 offset:7360
    ds_read_b64_tr_b16 v[58:59], v20 offset:8256
    s_waitcnt vmcnt(23)
    s_waitcnt lgkmcnt(10)
    v_mfma_f32_32x32x16_bf16 v[104:119], v[32:35], a[120:123], v[104:119]
    ds_read_b64_tr_b16 v[64:65], v20 offset:8960
    ds_read_b64_tr_b16 v[66:67], v20 offset:9856
    v_mfma_f32_32x32x16_bf16 v[120:135], v[36:39], a[120:123], v[120:135]
    ds_read_b64_tr_b16 v[68:69], v20 offset:8992
    ds_read_b64_tr_b16 v[70:71], v20 offset:9888
    s_waitcnt lgkmcnt(10)
    v_mfma_f32_32x32x16_bf16 v[136:151], v[40:43], a[120:123], v[136:151]
    ds_read_b64_tr_b16 v[72:73], v20 offset:9024
    ds_read_b64_tr_b16 v[74:75], v20 offset:9920
    v_mfma_f32_32x32x16_bf16 v[152:167], v[44:47], a[120:123], v[152:167]
    ds_read_b64_tr_b16 v[76:77], v20 offset:9056
    ds_read_b64_tr_b16 v[78:79], v20 offset:9952
    s_waitcnt lgkmcnt(10)
    v_mfma_f32_32x32x16_bf16 v[168:183], v[48:51], a[120:123], v[168:183]
    ds_read_b64_tr_b16 v[80:81], v20 offset:9088
    ds_read_b64_tr_b16 v[82:83], v20 offset:9984
    v_mfma_f32_32x32x16_bf16 v[184:199], v[52:55], a[120:123], v[184:199]
    ds_read_b64_tr_b16 v[84:85], v20 offset:9120
    ds_read_b64_tr_b16 v[86:87], v20 offset:10016
    s_waitcnt lgkmcnt(12)
    v_mfma_f32_32x32x16_bf16 v[200:215], v[56:59], a[120:123], v[200:215]
    ds_read_b64_tr_b16 v[88:89], v20 offset:9152
    ds_read_b64_tr_b16 v[90:91], v20 offset:10048
    s_waitcnt vmcnt(22)
    s_waitcnt lgkmcnt(12)
    v_mfma_f32_32x32x16_bf16 v[104:119], v[64:67], a[124:127], v[104:119]
    s_waitcnt lgkmcnt(10)
    v_mfma_f32_32x32x16_bf16 v[120:135], v[68:71], a[124:127], v[120:135]
    s_waitcnt lgkmcnt(8)
    v_mfma_f32_32x32x16_bf16 v[136:151], v[72:75], a[124:127], v[136:151]
    s_waitcnt lgkmcnt(6)
    v_mfma_f32_32x32x16_bf16 v[152:167], v[76:79], a[124:127], v[152:167]
    s_waitcnt lgkmcnt(4)
    v_mfma_f32_32x32x16_bf16 v[168:183], v[80:83], a[124:127], v[168:183]
    s_waitcnt lgkmcnt(2)
    v_mfma_f32_32x32x16_bf16 v[184:199], v[84:87], a[124:127], v[184:199]
    s_waitcnt lgkmcnt(0)
    v_mfma_f32_32x32x16_bf16 v[200:215], v[88:91], a[124:127], v[200:215]
    s_barrier
    s_mul_i32 s4, s32, 0x1c000
    s_mul_i32 s6, s55, 0x1c00
    s_add_u32 s34, s4, s6
    v_max_f32 v104, 0, v104
    v_max_f32 v105, 0, v105
    v_max_f32 v106, 0, v106
    v_max_f32 v107, 0, v107
    v_pk_mul_f32 v[104:105], v[104:105], v[108:109]
    v_pk_mul_f32 v[106:107], v[106:107], v[110:111]
    v_max_f32 v112, 0, v112
    v_max_f32 v113, 0, v113
    v_max_f32 v114, 0, v114
    v_max_f32 v115, 0, v115
    v_pk_mul_f32 v[112:113], v[112:113], v[116:117]
    v_pk_mul_f32 v[114:115], v[114:115], v[118:119]
    v_cvt_pk_bf16_f32 v96, v104, v105
    v_cvt_pk_bf16_f32 v97, v106, v107
    v_cvt_pk_bf16_f32 v98, v112, v113
    v_cvt_pk_bf16_f32 v99, v114, v115
    buffer_store_dwordx4 v[96:99], v2, s[12:15], s34 offen sc1
    v_max_f32 v120, 0, v120
    v_max_f32 v121, 0, v121
    v_max_f32 v122, 0, v122
    v_max_f32 v123, 0, v123
    v_pk_mul_f32 v[120:121], v[120:121], v[124:125]
    v_pk_mul_f32 v[122:123], v[122:123], v[126:127]
    v_max_f32 v128, 0, v128
    v_max_f32 v129, 0, v129
    v_max_f32 v130, 0, v130
    v_max_f32 v131, 0, v131
    v_pk_mul_f32 v[128:129], v[128:129], v[132:133]
    v_pk_mul_f32 v[130:131], v[130:131], v[134:135]
    v_cvt_pk_bf16_f32 v100, v120, v121
    v_cvt_pk_bf16_f32 v101, v122, v123
    v_cvt_pk_bf16_f32 v102, v128, v129
    v_cvt_pk_bf16_f32 v103, v130, v131
    buffer_store_dwordx4 v[100:103], v2, s[12:15], s34 offen offset:1024 sc1
    v_max_f32 v136, 0, v136
    v_max_f32 v137, 0, v137
    v_max_f32 v138, 0, v138
    v_max_f32 v139, 0, v139
    v_pk_mul_f32 v[136:137], v[136:137], v[140:141]
    v_pk_mul_f32 v[138:139], v[138:139], v[142:143]
    v_max_f32 v144, 0, v144
    v_max_f32 v145, 0, v145
    v_max_f32 v146, 0, v146
    v_max_f32 v147, 0, v147
    v_pk_mul_f32 v[144:145], v[144:145], v[148:149]
    v_pk_mul_f32 v[146:147], v[146:147], v[150:151]
    v_cvt_pk_bf16_f32 v96, v136, v137
    v_cvt_pk_bf16_f32 v97, v138, v139
    v_cvt_pk_bf16_f32 v98, v144, v145
    v_cvt_pk_bf16_f32 v99, v146, v147
    buffer_store_dwordx4 v[96:99], v2, s[12:15], s34 offen offset:2048 sc1
    v_max_f32 v152, 0, v152
    v_max_f32 v153, 0, v153
    v_max_f32 v154, 0, v154
    v_max_f32 v155, 0, v155
    v_pk_mul_f32 v[152:153], v[152:153], v[156:157]
    v_pk_mul_f32 v[154:155], v[154:155], v[158:159]
    v_max_f32 v160, 0, v160
    v_max_f32 v161, 0, v161
    v_max_f32 v162, 0, v162
    v_max_f32 v163, 0, v163
    v_pk_mul_f32 v[160:161], v[160:161], v[164:165]
    v_pk_mul_f32 v[162:163], v[162:163], v[166:167]
    v_cvt_pk_bf16_f32 v100, v152, v153
    v_cvt_pk_bf16_f32 v101, v154, v155
    v_cvt_pk_bf16_f32 v102, v160, v161
    v_cvt_pk_bf16_f32 v103, v162, v163
    buffer_store_dwordx4 v[100:103], v2, s[12:15], s34 offen offset:3072 sc1
    v_max_f32 v168, 0, v168
    v_max_f32 v169, 0, v169
    v_max_f32 v170, 0, v170
    v_max_f32 v171, 0, v171
    v_pk_mul_f32 v[168:169], v[168:169], v[172:173]
    v_pk_mul_f32 v[170:171], v[170:171], v[174:175]
    v_max_f32 v176, 0, v176
    v_max_f32 v177, 0, v177
    v_max_f32 v178, 0, v178
    v_max_f32 v179, 0, v179
    v_pk_mul_f32 v[176:177], v[176:177], v[180:181]
    v_pk_mul_f32 v[178:179], v[178:179], v[182:183]
    v_cvt_pk_bf16_f32 v96, v168, v169
    v_cvt_pk_bf16_f32 v97, v170, v171
    v_cvt_pk_bf16_f32 v98, v176, v177
    v_cvt_pk_bf16_f32 v99, v178, v179
    s_add_u32 s34, s34, 0x1000
    buffer_store_dwordx4 v[96:99], v2, s[12:15], s34 offen sc1
    v_max_f32 v184, 0, v184
    v_max_f32 v185, 0, v185
    v_max_f32 v186, 0, v186
    v_max_f32 v187, 0, v187
    v_pk_mul_f32 v[184:185], v[184:185], v[188:189]
    v_pk_mul_f32 v[186:187], v[186:187], v[190:191]
    v_max_f32 v192, 0, v192
    v_max_f32 v193, 0, v193
    v_max_f32 v194, 0, v194
    v_max_f32 v195, 0, v195
    v_pk_mul_f32 v[192:193], v[192:193], v[196:197]
    v_pk_mul_f32 v[194:195], v[194:195], v[198:199]
    v_cvt_pk_bf16_f32 v100, v184, v185
    v_cvt_pk_bf16_f32 v101, v186, v187
    v_cvt_pk_bf16_f32 v102, v192, v193
    v_cvt_pk_bf16_f32 v103, v194, v195
    buffer_store_dwordx4 v[100:103], v2, s[12:15], s34 offen offset:1024 sc1
    v_max_f32 v200, 0, v200
    v_max_f32 v201, 0, v201
    v_max_f32 v202, 0, v202
    v_max_f32 v203, 0, v203
    v_pk_mul_f32 v[200:201], v[200:201], v[204:205]
    v_pk_mul_f32 v[202:203], v[202:203], v[206:207]
    v_max_f32 v208, 0, v208
    v_max_f32 v209, 0, v209
    v_max_f32 v210, 0, v210
    v_max_f32 v211, 0, v211
    v_pk_mul_f32 v[208:209], v[208:209], v[212:213]
    v_pk_mul_f32 v[210:211], v[210:211], v[214:215]
    v_cvt_pk_bf16_f32 v96, v200, v201
    v_cvt_pk_bf16_f32 v97, v202, v203
    v_cvt_pk_bf16_f32 v98, v208, v209
    v_cvt_pk_bf16_f32 v99, v210, v211
    buffer_store_dwordx4 v[96:99], v2, s[12:15], s34 offen offset:2048 sc1
    s_add_u32 s63, s58, 0x2c000
    s_add_u32 m0, s59, 0x16000
    s_nop 0
    buffer_load_dwordx4 v248, s[28:31], s63 offen lds
    s_add_u32 m0, s59, 0x16000
    s_nop 0
    buffer_load_dwordx4 v249, s[28:31], s63 offen offset:1024 lds
    s_add_u32 s63, s58, 0x30000
    s_add_u32 m0, s59, 0x18000
    s_nop 0
    buffer_load_dwordx4 v248, s[28:31], s63 offen lds
    s_add_u32 m0, s59, 0x18000
    s_nop 0
    buffer_load_dwordx4 v249, s[28:31], s63 offen offset:1024 lds
    s_add_u32 s63, s58, 0x34000
    s_add_u32 m0, s59, 0x1a000
    s_nop 0
    buffer_load_dwordx4 v248, s[28:31], s63 offen lds
    s_add_u32 m0, s59, 0x1a000
    s_nop 0
    buffer_load_dwordx4 v249, s[28:31], s63 offen offset:1024 lds
    s_add_u32 s63, s58, 0x38000
    s_add_u32 m0, s59, 0x1c000
    s_nop 0
    buffer_load_dwordx4 v248, s[28:31], s63 offen lds
    s_add_u32 m0, s59, 0x1c000
    s_nop 0
    buffer_load_dwordx4 v249, s[28:31], s63 offen offset:1024 lds
    s_add_u32 s63, s58, 0x3c000
    s_add_u32 m0, s59, 0x1e000
    s_nop 0
    buffer_load_dwordx4 v248, s[28:31], s63 offen lds
    s_add_u32 m0, s59, 0x1e000
    s_nop 0
    buffer_load_dwordx4 v249, s[28:31], s63 offen offset:1024 lds
    s_add_u32 s42, s54, 32
    s_waitcnt vmcnt(10)
    s_barrier
    s_cmp_lg_u32 s3, 0
    s_cbranch_scc1 ARR_21
    s_lshl_b32 s60, s42, 8
    v_mov_b32 v253, 0
    v_mov_b32 v254, 1
    s_mov_b64 exec, 1
    buffer_atomic_add v254, v253, s[84:87], s60 offen sc1
    s_mov_b64 exec, -1
ARR_21:
    s_add_u32 s63, s58, 0x40000
    s_add_u32 m0, s59, 0x20000
    s_nop 0
    buffer_load_dwordx4 v248, s[28:31], s63 offen lds
    s_add_u32 m0, s59, 0x20000
    s_nop 0
    buffer_load_dwordx4 v249, s[28:31], s63 offen offset:1024 lds
    s_add_u32 s63, s58, 0x44000
    s_add_u32 m0, s59, 0x22000
    s_nop 0
    buffer_load_dwordx4 v248, s[28:31], s63 offen lds
    s_add_u32 m0, s59, 0x22000
    s_nop 0
    buffer_load_dwordx4 v249, s[28:31], s63 offen offset:1024 lds
    s_add_u32 s63, s58, 0x48000
    s_add_u32 m0, s59, 0x24000
    s_nop 0
    buffer_load_dwordx4 v248, s[28:31], s63 offen lds
    s_add_u32 m0, s59, 0x24000
    s_nop 0
    buffer_load_dwordx4 v249, s[28:31], s63 offen offset:1024 lds
    s_add_u32 s63, s58, 0x4c000
    s_add_u32 m0, s59, 0x26000
    s_nop 0
    buffer_load_dwordx4 v248, s[28:31], s63 offen lds
    s_add_u32 m0, s59, 0x26000
    s_nop 0
    buffer_load_dwordx4 v249, s[28:31], s63 offen offset:1024 lds
    v_lshlrev_b32 v2, 4, v1
    v_and_b32 v3, 31, v1
    v_lshrrev_b32 v4, 5, v1
    s_and_b32 s38, s3, 1
    s_lshr_b32 s39, s3, 1
    s_add_u32 s12, s82, 0x800000
    s_addc_u32 s13, s83, 0
    s_mov_b32 s14, 0x700000
    s_mov_b32 s15, 0x20000
    s_mov_b32 s16, s78
    s_mov_b32 s17, s79
    s_mov_b32 s18, 0x200000
    s_mov_b32 s19, 0x20000
    s_lshl_b32 s4, s56, 1
    s_add_u32 s5, s4, s39
    s_mul_i32 s36, s5, 0x1c000
    s_xor_b32 s5, s39, 1
    s_add_u32 s5, s4, s5
    s_mul_i32 s37, s5, 0x1c000
    s_mul_i32 s4, s3, 0x7000
    s_add_u32 s36, s36, s4
    s_add_u32 s37, s37, s4
    v_bfe_u32 v5, v1, 2, 2
    v_lshl_add_u32 v6, v4, 3, v5
    v_lshlrev_b32 v6, 7, v6
    v_bfe_u32 v7, v1, 3, 1
    v_xor_b32 v7, s38, v7
    v_lshl_add_u32 v6, v7, 6, v6
    v_and_b32 v7, 1, v1
    v_lshl_add_u32 v6, v7, 5, v6
    v_bfe_u32 v7, v1, 4, 1
    v_lshl_add_u32 v6, v7, 4, v6
    v_bfe_u32 v7, v1, 1, 1
    v_lshl_add_u32 v6, v7, 3, v6
    v_add_u32 v14, s59, v6
    v_xor_b32 v17, 64, v14
    v_add_u32 v15, 0x10000, v14
    v_add_u32 v16, 0x20000, v14
    v_add_u32 v18, 0x10000, v17
    v_add_u32 v19, 0x20000, v17
    s_lshl_b32 s4, s56, 6
    s_lshl_b32 s5, s39, 5
    s_add_u32 s4, s4, s5
    v_add_u32 v20, s4, v3
    s_lshr_b32 s42, s56, 1
    s_add_u32 s42, s42, 32
    s_lshl_b32 s61, s42, 8
    s_cmp_eq_u32 s3, 0
    s_cselect_b32 s60, 0, 0x7ff00000
    v_lshlrev_b32 v250, 8, v1
    v_add_u32 v250, s60, v250
    ds_read_b64_tr_b16 v[136:137], v14 offset:0
    ds_read_b64_tr_b16 v[138:139], v14 offset:512
    ds_read_b64_tr_b16 v[140:141], v17 offset:0
    ds_read_b64_tr_b16 v[142:143], v17 offset:512
    ds_read_b64_tr_b16 v[144:145], v14 offset:8192
    ds_read_b64_tr_b16 v[146:147], v14 offset:8704
    ds_read_b64_tr_b16 v[148:149], v17 offset:8192
    ds_read_b64_tr_b16 v[150:151], v17 offset:8704
    ds_read_b64_tr_b16 v[152:153], v14 offset:16384
    ds_read_b64_tr_b16 v[154:155], v14 offset:16896
    ds_read_b64_tr_b16 v[156:157], v17 offset:16384
    ds_read_b64_tr_b16 v[158:159], v17 offset:16896
    s_waitcnt lgkmcnt(4)
    ds_read_b64_tr_b16 v[160:161], v14 offset:24576
    ds_read_b64_tr_b16 v[162:163], v14 offset:25088
    ds_read_b64_tr_b16 v[164:165], v17 offset:24576
    ds_read_b64_tr_b16 v[166:167], v17 offset:25088
    ds_read_b64_tr_b16 v[168:169], v14 offset:32768
    ds_read_b64_tr_b16 v[170:171], v14 offset:33280
    ds_read_b64_tr_b16 v[172:173], v17 offset:32768
    ds_read_b64_tr_b16 v[174:175], v17 offset:33280
    ds_read_b64_tr_b16 v[176:177], v14 offset:40960
    ds_read_b64_tr_b16 v[178:179], v14 offset:41472
    ds_read_b64_tr_b16 v[180:181], v17 offset:40960
    ds_read_b64_tr_b16 v[182:183], v17 offset:41472
    s_waitcnt lgkmcnt(4)
    ds_read_b64_tr_b16 v[184:185], v14 offset:49152
    ds_read_b64_tr_b16 v[186:187], v14 offset:49664
    ds_read_b64_tr_b16 v[188:189], v17 offset:49152
    ds_read_b64_tr_b16 v[190:191], v17 offset:49664
    ds_read_b64_tr_b16 v[192:193], v14 offset:57344
    ds_read_b64_tr_b16 v[194:195], v14 offset:57856
    ds_read_b64_tr_b16 v[196:197], v17 offset:57344
    ds_read_b64_tr_b16 v[198:199], v17 offset:57856
    s_waitcnt lgkmcnt(0)
    s_add_u32 s63, s58, 0x50000
    s_add_u32 m0, s59, 0
    s_nop 0
    buffer_load_dwordx4 v248, s[28:31], s63 offen lds
    s_add_u32 m0, s59, 0
    s_nop 0
    buffer_load_dwordx4 v249, s[28:31], s63 offen offset:1024 lds
    s_add_u32 s63, s58, 0x54000
    s_add_u32 m0, s59, 0x2000
    s_nop 0
    buffer_load_dwordx4 v248, s[28:31], s63 offen lds
    s_add_u32 m0, s59, 0x2000
    s_nop 0
    buffer_load_dwordx4 v249, s[28:31], s63 offen offset:1024 lds
    s_add_u32 s63, s58, 0x58000
    s_add_u32 m0, s59, 0x4000
    s_nop 0
    buffer_load_dwordx4 v248, s[28:31], s63 offen lds
    s_add_u32 m0, s59, 0x4000
    s_nop 0
    buffer_load_dwordx4 v249, s[28:31], s63 offen offset:1024 lds
    s_add_u32 s63, s58, 0x5c000
    s_add_u32 m0, s59, 0x6000
    s_nop 0
    buffer_load_dwordx4 v248, s[28:31], s63 offen lds
    s_add_u32 m0, s59, 0x6000
    s_nop 0
    buffer_load_dwordx4 v249, s[28:31], s63 offen offset:1024 lds
    s_mov_b64 exec, 1
    buffer_load_dword v252, v250, s[84:87], s61 offen sc1
    s_mov_b64 exec, -1
    s_add_u32 s63, s58, 0x60000
    s_add_u32 m0, s59, 0x8000
    s_nop 0
    buffer_load_dwordx4 v248, s[28:31], s63 offen lds
    s_add_u32 m0, s59, 0x8000
    s_nop 0
    buffer_load_dwordx4 v249, s[28:31], s63 offen offset:1024 lds
    s_add_u32 s63, s58, 0x64000
    s_add_u32 m0, s59, 0xa000
    s_nop 0
    buffer_load_dwordx4 v248, s[28:31], s63 offen lds
    s_add_u32 m0, s59, 0xa000
    s_nop 0
    buffer_load_dwordx4 v249, s[28:31], s63 offen offset:1024 lds
    s_add_u32 s63, s58, 0x68000
    s_add_u32 m0, s59, 0xc000
    s_nop 0
    buffer_load_dwordx4 v248, s[28:31], s63 offen lds
    s_add_u32 m0, s59, 0xc000
    s_nop 0
    buffer_load_dwordx4 v249, s[28:31], s63 offen offset:1024 lds
    s_add_u32 s63, s58, 0x6c000
    s_add_u32 m0, s59, 0xe000
    s_nop 0
    buffer_load_dwordx4 v248, s[28:31], s63 offen lds
    s_add_u32 m0, s59, 0xe000
    s_nop 0
    buffer_load_dwordx4 v249, s[28:31], s63 offen offset:1024 lds
    s_cmp_lg_u32 s3, 0
    s_cbranch_scc1 WSK_22
    s_mov_b32 s60, 0x61a80
    s_mov_b64 exec, 1
    s_waitcnt vmcnt(8)
    v_cmp_ne_u32 vcc, 16, v252
    s_nop 4
    s_cbranch_vccz PDN_24
POLL_23:
    buffer_load_dword v251, v250, s[84:87], s61 offen sc1
    s_waitcnt vmcnt(0)
    v_cmp_ne_u32 vcc, 16, v251
    s_sub_u32 s60, s60, 1
    s_cmp_eq_u32 s60, 0
    s_cbranch_scc1 PDN_24
    s_nop 1
    s_cbranch_vccz PDN_24
    s_sleep 1
    s_branch POLL_23
PDN_24:
    s_mov_b64 exec, -1
WSK_22:
    s_barrier
    s_add_u32 s40, s36, 0
    s_add_u32 s41, s37, 0
    buffer_load_dwordx4 a[0:3], v2, s[12:15], s40 offen sc1
    buffer_load_dwordx4 a[4:7], v2, s[12:15], s41 offen sc1
    buffer_load_dwordx4 a[8:11], v2, s[12:15], s40 offen offset:1024 sc1
    buffer_load_dwordx4 a[12:15], v2, s[12:15], s41 offen offset:1024 sc1
    buffer_load_dwordx4 a[16:19], v2, s[12:15], s40 offen offset:2048 sc1
    buffer_load_dwordx4 a[20:23], v2, s[12:15], s41 offen offset:2048 sc1
    buffer_load_dwordx4 a[24:27], v2, s[12:15], s40 offen offset:3072 sc1
    buffer_load_dwordx4 a[28:31], v2, s[12:15], s41 offen offset:3072 sc1
    s_add_u32 s40, s36, 0x1000
    s_add_u32 s41, s37, 0x1000
    buffer_load_dwordx4 a[32:35], v2, s[12:15], s40 offen sc1
    buffer_load_dwordx4 a[36:39], v2, s[12:15], s41 offen sc1
    buffer_load_dwordx4 a[40:43], v2, s[12:15], s40 offen offset:1024 sc1
    buffer_load_dwordx4 a[44:47], v2, s[12:15], s41 offen offset:1024 sc1
    s_add_u32 s20, s82, 0xf10000
    s_addc_u32 s21, s83, 0
    s_mov_b32 s22, 0x20000
    s_mov_b32 s23, 0x20000
    s_lshl_b32 s4, s56, 1
    s_add_u32 s4, s4, s39
    s_lshl_b32 s43, s4, 11
    s_waitcnt vmcnt(10)
    v_mfma_f32_32x32x16_bf16 v[72:87], v[136:139], a[0:3], 0
    v_mfma_f32_32x32x16_bf16 v[104:119], v[136:139], a[4:7], 0
    v_mfma_f32_32x32x16_bf16 v[88:103], v[140:143], a[0:3], 0
    v_mfma_f32_32x32x16_bf16 v[120:135], v[140:143], a[4:7], 0
    buffer_load_dwordx4 a[48:51], v2, s[12:15], s40 offen offset:2048 sc1
    buffer_load_dwordx4 a[52:55], v2, s[12:15], s41 offen offset:2048 sc1
    s_waitcnt vmcnt(10)
    v_mfma_f32_32x32x16_bf16 v[72:87], v[144:147], a[8:11], v[72:87]
    v_mfma_f32_32x32x16_bf16 v[104:119], v[144:147], a[12:15], v[104:119]
    v_mfma_f32_32x32x16_bf16 v[88:103], v[148:151], a[8:11], v[88:103]
    v_mfma_f32_32x32x16_bf16 v[120:135], v[148:151], a[12:15], v[120:135]
    buffer_load_dwordx4 a[56:59], v2, s[12:15], s40 offen offset:3072 sc1
    buffer_load_dwordx4 a[60:63], v2, s[12:15], s41 offen offset:3072 sc1
    s_waitcnt vmcnt(10)
    v_mfma_f32_32x32x16_bf16 v[72:87], v[152:155], a[16:19], v[72:87]
    v_mfma_f32_32x32x16_bf16 v[104:119], v[152:155], a[20:23], v[104:119]
    v_mfma_f32_32x32x16_bf16 v[88:103], v[156:159], a[16:19], v[88:103]
    v_mfma_f32_32x32x16_bf16 v[120:135], v[156:159], a[20:23], v[120:135]
    s_add_u32 s40, s36, 0x2000
    s_add_u32 s41, s37, 0x2000
    buffer_load_dwordx4 a[64:67], v2, s[12:15], s40 offen sc1
    buffer_load_dwordx4 a[68:71], v2, s[12:15], s41 offen sc1
    s_waitcnt vmcnt(10)
    v_mfma_f32_32x32x16_bf16 v[72:87], v[160:163], a[24:27], v[72:87]
    v_mfma_f32_32x32x16_bf16 v[104:119], v[160:163], a[28:31], v[104:119]
    v_mfma_f32_32x32x16_bf16 v[88:103], v[164:167], a[24:27], v[88:103]
    v_mfma_f32_32x32x16_bf16 v[120:135], v[164:167], a[28:31], v[120:135]
    buffer_load_dwordx4 a[72:75], v2, s[12:15], s40 offen offset:1024 sc1
    buffer_load_dwordx4 a[76:79], v2, s[12:15], s41 offen offset:1024 sc1
    s_waitcnt vmcnt(10)
    v_mfma_f32_32x32x16_bf16 v[72:87], v[168:171], a[32:35], v[72:87]
    v_mfma_f32_32x32x16_bf16 v[104:119], v[168:171], a[36:39], v[104:119]
    v_mfma_f32_32x32x16_bf16 v[88:103], v[172:175], a[32:35], v[88:103]
    v_mfma_f32_32x32x16_bf16 v[120:135], v[172:175], a[36:39], v[120:135]
    buffer_load_dwordx4 a[80:83], v2, s[12:15], s40 offen offset:2048 sc1
    buffer_load_dwordx4 a[84:87], v2, s[12:15], s41 offen offset:2048 sc1
    s_waitcnt vmcnt(10)
    v_mfma_f32_32x32x16_bf16 v[72:87], v[176:179], a[40:43], v[72:87]
    v_mfma_f32_32x32x16_bf16 v[104:119], v[176:179], a[44:47], v[104:119]
    v_mfma_f32_32x32x16_bf16 v[88:103], v[180:183], a[40:43], v[88:103]
    v_mfma_f32_32x32x16_bf16 v[120:135], v[180:183], a[44:47], v[120:135]
    buffer_load_dwordx4 a[88:91], v2, s[12:15], s40 offen offset:3072 sc1
    buffer_load_dwordx4 a[92:95], v2, s[12:15], s41 offen offset:3072 sc1
    s_waitcnt vmcnt(10)
    v_mfma_f32_32x32x16_bf16 v[72:87], v[184:187], a[48:51], v[72:87]
    v_mfma_f32_32x32x16_bf16 v[104:119], v[184:187], a[52:55], v[104:119]
    v_mfma_f32_32x32x16_bf16 v[88:103], v[188:191], a[48:51], v[88:103]
    v_mfma_f32_32x32x16_bf16 v[120:135], v[188:191], a[52:55], v[120:135]
    s_add_u32 s40, s36, 0x3000
    s_add_u32 s41, s37, 0x3000
    buffer_load_dwordx4 a[96:99], v2, s[12:15], s40 offen sc1
    buffer_load_dwordx4 a[100:103], v2, s[12:15], s41 offen sc1
    ds_read_b64_tr_b16 v[44:45], v15 offset:0
    ds_read_b64_tr_b16 v[46:47], v15 offset:512
    ds_read_b64_tr_b16 v[48:49], v18 offset:0
    ds_read_b64_tr_b16 v[50:51], v18 offset:512
    s_waitcnt vmcnt(10)
    v_mfma_f32_32x32x16_bf16 v[72:87], v[192:195], a[56:59], v[72:87]
    v_mfma_f32_32x32x16_bf16 v[104:119], v[192:195], a[60:63], v[104:119]
    v_mfma_f32_32x32x16_bf16 v[88:103], v[196:199], a[56:59], v[88:103]
    v_mfma_f32_32x32x16_bf16 v[120:135], v[196:199], a[60:63], v[120:135]
    buffer_load_dwordx4 a[104:107], v2, s[12:15], s40 offen offset:1024 sc1
    buffer_load_dwordx4 a[108:111], v2, s[12:15], s41 offen offset:1024 sc1
    ds_read_b64_tr_b16 v[52:53], v15 offset:8192
    ds_read_b64_tr_b16 v[54:55], v15 offset:8704
    ds_read_b64_tr_b16 v[56:57], v18 offset:8192
    ds_read_b64_tr_b16 v[58:59], v18 offset:8704
    s_waitcnt vmcnt(10)
    s_waitcnt lgkmcnt(4)
    v_mfma_f32_32x32x16_bf16 v[72:87], v[44:47], a[64:67], v[72:87]
    v_mfma_f32_32x32x16_bf16 v[104:119], v[44:47], a[68:71], v[104:119]
    v_mfma_f32_32x32x16_bf16 v[88:103], v[48:51], a[64:67], v[88:103]
    v_mfma_f32_32x32x16_bf16 v[120:135], v[48:51], a[68:71], v[120:135]
    buffer_load_dwordx4 a[112:115], v2, s[12:15], s40 offen offset:2048 sc1
    buffer_load_dwordx4 a[116:119], v2, s[12:15], s41 offen offset:2048 sc1
    ds_read_b64_tr_b16 v[44:45], v15 offset:16384
    ds_read_b64_tr_b16 v[46:47], v15 offset:16896
    ds_read_b64_tr_b16 v[48:49], v18 offset:16384
    ds_read_b64_tr_b16 v[50:51], v18 offset:16896
    s_waitcnt vmcnt(10)
    s_waitcnt lgkmcnt(4)
    v_mfma_f32_32x32x16_bf16 v[72:87], v[52:55], a[72:75], v[72:87]
    v_mfma_f32_32x32x16_bf16 v[104:119], v[52:55], a[76:79], v[104:119]
    v_mfma_f32_32x32x16_bf16 v[88:103], v[56:59], a[72:75], v[88:103]
    v_mfma_f32_32x32x16_bf16 v[120:135], v[56:59], a[76:79], v[120:135]
    buffer_load_dwordx4 a[120:123], v2, s[12:15], s40 offen offset:3072 sc1
    buffer_load_dwordx4 a[124:127], v2, s[12:15], s41 offen offset:3072 sc1
    ds_read_b64_tr_b16 v[52:53], v15 offset:24576
    ds_read_b64_tr_b16 v[54:55], v15 offset:25088
    ds_read_b64_tr_b16 v[56:57], v18 offset:24576
    ds_read_b64_tr_b16 v[58:59], v18 offset:25088
    s_waitcnt vmcnt(10)
    s_waitcnt lgkmcnt(4)
    v_mfma_f32_32x32x16_bf16 v[72:87], v[44:47], a[80:83], v[72:87]
    v_mfma_f32_32x32x16_bf16 v[104:119], v[44:47], a[84:87], v[104:119]
    v_mfma_f32_32x32x16_bf16 v[88:103], v[48:51], a[80:83], v[88:103]
    v_mfma_f32_32x32x16_bf16 v[120:135], v[48:51], a[84:87], v[120:135]
    s_add_u32 s40, s36, 0x4000
    s_add_u32 s41, s37, 0x4000
    buffer_load_dwordx4 a[128:131], v2, s[12:15], s40 offen sc1
    buffer_load_dwordx4 a[132:135], v2, s[12:15], s41 offen sc1
    ds_read_b64_tr_b16 v[44:45], v15 offset:32768
    ds_read_b64_tr_b16 v[46:47], v15 offset:33280
    ds_read_b64_tr_b16 v[48:49], v18 offset:32768
    ds_read_b64_tr_b16 v[50:51], v18 offset:33280
    s_waitcnt vmcnt(10)
    s_waitcnt lgkmcnt(4)
    v_mfma_f32_32x32x16_bf16 v[72:87], v[52:55], a[88:91], v[72:87]
    v_mfma_f32_32x32x16_bf16 v[104:119], v[52:55], a[92:95], v[104:119]
    v_mfma_f32_32x32x16_bf16 v[88:103], v[56:59], a[88:91], v[88:103]
    v_mfma_f32_32x32x16_bf16 v[120:135], v[56:59], a[92:95], v[120:135]
    buffer_load_dwordx4 a[136:139], v2, s[12:15], s40 offen offset:1024 sc1
    buffer_load_dwordx4 a[140:143], v2, s[12:15], s41 offen offset:1024 sc1
    ds_read_b64_tr_b16 v[52:53], v15 offset:40960
    ds_read_b64_tr_b16 v[54:55], v15 offset:41472
    ds_read_b64_tr_b16 v[56:57], v18 offset:40960
    ds_read_b64_tr_b16 v[58:59], v18 offset:41472
    s_waitcnt vmcnt(10)
    s_waitcnt lgkmcnt(4)
    v_mfma_f32_32x32x16_bf16 v[72:87], v[44:47], a[96:99], v[72:87]
    v_mfma_f32_32x32x16_bf16 v[104:119], v[44:47], a[100:103], v[104:119]
    v_mfma_f32_32x32x16_bf16 v[88:103], v[48:51], a[96:99], v[88:103]
    v_mfma_f32_32x32x16_bf16 v[120:135], v[48:51], a[100:103], v[120:135]
    buffer_load_dwordx4 a[144:147], v2, s[12:15], s40 offen offset:2048 sc1
    buffer_load_dwordx4 a[148:151], v2, s[12:15], s41 offen offset:2048 sc1
    ds_read_b64_tr_b16 v[44:45], v15 offset:49152
    ds_read_b64_tr_b16 v[46:47], v15 offset:49664
    ds_read_b64_tr_b16 v[48:49], v18 offset:49152
    ds_read_b64_tr_b16 v[50:51], v18 offset:49664
    s_waitcnt vmcnt(10)
    s_waitcnt lgkmcnt(4)
    v_mfma_f32_32x32x16_bf16 v[72:87], v[52:55], a[104:107], v[72:87]
    v_mfma_f32_32x32x16_bf16 v[104:119], v[52:55], a[108:111], v[104:119]
    v_mfma_f32_32x32x16_bf16 v[88:103], v[56:59], a[104:107], v[88:103]
    v_mfma_f32_32x32x16_bf16 v[120:135], v[56:59], a[108:111], v[120:135]
    buffer_load_dwordx4 a[152:155], v2, s[12:15], s40 offen offset:3072 sc1
    buffer_load_dwordx4 a[156:159], v2, s[12:15], s41 offen offset:3072 sc1
    ds_read_b64_tr_b16 v[52:53], v15 offset:57344
    ds_read_b64_tr_b16 v[54:55], v15 offset:57856
    ds_read_b64_tr_b16 v[56:57], v18 offset:57344
    ds_read_b64_tr_b16 v[58:59], v18 offset:57856
    s_waitcnt vmcnt(10)
    s_waitcnt lgkmcnt(4)
    v_mfma_f32_32x32x16_bf16 v[72:87], v[44:47], a[112:115], v[72:87]
    v_mfma_f32_32x32x16_bf16 v[104:119], v[44:47], a[116:119], v[104:119]
    v_mfma_f32_32x32x16_bf16 v[88:103], v[48:51], a[112:115], v[88:103]
    v_mfma_f32_32x32x16_bf16 v[120:135], v[48:51], a[116:119], v[120:135]
    s_add_u32 s40, s36, 0x5000
    s_add_u32 s41, s37, 0x5000
    buffer_load_dwordx4 a[160:163], v2, s[12:15], s40 offen sc1
    buffer_load_dwordx4 a[164:167], v2, s[12:15], s41 offen sc1
    ds_read_b64_tr_b16 v[44:45], v16 offset:0
    ds_read_b64_tr_b16 v[46:47], v16 offset:512
    ds_read_b64_tr_b16 v[48:49], v19 offset:0
    ds_read_b64_tr_b16 v[50:51], v19 offset:512
    s_waitcnt vmcnt(10)
    s_waitcnt lgkmcnt(4)
    v_mfma_f32_32x32x16_bf16 v[72:87], v[52:55], a[120:123], v[72:87]
    v_mfma_f32_32x32x16_bf16 v[104:119], v[52:55], a[124:127], v[104:119]
    v_mfma_f32_32x32x16_bf16 v[88:103], v[56:59], a[120:123], v[88:103]
    v_mfma_f32_32x32x16_bf16 v[120:135], v[56:59], a[124:127], v[120:135]
    buffer_load_dwordx4 a[168:171], v2, s[12:15], s40 offen offset:1024 sc1
    buffer_load_dwordx4 a[172:175], v2, s[12:15], s41 offen offset:1024 sc1
    ds_read_b64_tr_b16 v[52:53], v16 offset:8192
    ds_read_b64_tr_b16 v[54:55], v16 offset:8704
    ds_read_b64_tr_b16 v[56:57], v19 offset:8192
    ds_read_b64_tr_b16 v[58:59], v19 offset:8704
    s_waitcnt vmcnt(10)
    s_waitcnt lgkmcnt(4)
    v_mfma_f32_32x32x16_bf16 v[72:87], v[44:47], a[128:131], v[72:87]
    v_mfma_f32_32x32x16_bf16 v[104:119], v[44:47], a[132:135], v[104:119]
    v_mfma_f32_32x32x16_bf16 v[88:103], v[48:51], a[128:131], v[88:103]
    v_mfma_f32_32x32x16_bf16 v[120:135], v[48:51], a[132:135], v[120:135]
    buffer_load_dwordx4 a[176:179], v2, s[12:15], s40 offen offset:2048 sc1
    buffer_load_dwordx4 a[180:183], v2, s[12:15], s41 offen offset:2048 sc1
    s_add_u32 m0, s59, 0x10000
    s_nop 0
    buffer_load_dwordx4 v2, s[20:23], s43 offen sc1 lds
    buffer_load_dwordx4 v2, s[20:23], s43 offen offset:1024 sc1 lds
    ds_read_b64_tr_b16 v[44:45], v16 offset:16384
    ds_read_b64_tr_b16 v[46:47], v16 offset:16896
    ds_read_b64_tr_b16 v[48:49], v19 offset:16384
    ds_read_b64_tr_b16 v[50:51], v19 offset:16896
    s_waitcnt vmcnt(12)
    s_waitcnt lgkmcnt(4)
    v_mfma_f32_32x32x16_bf16 v[72:87], v[52:55], a[136:139], v[72:87]
    v_mfma_f32_32x32x16_bf16 v[104:119], v[52:55], a[140:143], v[104:119]
    v_mfma_f32_32x32x16_bf16 v[88:103], v[56:59], a[136:139], v[88:103]
    v_mfma_f32_32x32x16_bf16 v[120:135], v[56:59], a[140:143], v[120:135]
    buffer_load_dwordx4 a[184:187], v2, s[12:15], s40 offen offset:3072 sc1
    buffer_load_dwordx4 a[188:191], v2, s[12:15], s41 offen offset:3072 sc1
    ds_read_b64_tr_b16 v[52:53], v16 offset:24576
    ds_read_b64_tr_b16 v[54:55], v16 offset:25088
    ds_read_b64_tr_b16 v[56:57], v19 offset:24576
    ds_read_b64_tr_b16 v[58:59], v19 offset:25088
    s_waitcnt vmcnt(12)
    s_waitcnt lgkmcnt(4)
    v_mfma_f32_32x32x16_bf16 v[72:87], v[44:47], a[144:147], v[72:87]
    v_mfma_f32_32x32x16_bf16 v[104:119], v[44:47], a[148:151], v[104:119]
    v_mfma_f32_32x32x16_bf16 v[88:103], v[48:51], a[144:147], v[88:103]
    v_mfma_f32_32x32x16_bf16 v[120:135], v[48:51], a[148:151], v[120:135]
    s_add_u32 s40, s36, 0x6000
    s_add_u32 s41, s37, 0x6000
    buffer_load_dwordx4 a[192:195], v2, s[12:15], s40 offen sc1
    buffer_load_dwordx4 a[196:199], v2, s[12:15], s41 offen sc1
    ds_read_b64_tr_b16 v[44:45], v14 offset:0
    ds_read_b64_tr_b16 v[46:47], v14 offset:512
    ds_read_b64_tr_b16 v[48:49], v17 offset:0
    ds_read_b64_tr_b16 v[50:51], v17 offset:512
    s_waitcnt vmcnt(12)
    s_waitcnt lgkmcnt(4)
    v_mfma_f32_32x32x16_bf16 v[72:87], v[52:55], a[152:155], v[72:87]
    v_mfma_f32_32x32x16_bf16 v[104:119], v[52:55], a[156:159], v[104:119]
    v_mfma_f32_32x32x16_bf16 v[88:103], v[56:59], a[152:155], v[88:103]
    v_mfma_f32_32x32x16_bf16 v[120:135], v[56:59], a[156:159], v[120:135]
    buffer_load_dwordx4 a[200:203], v2, s[12:15], s40 offen offset:1024 sc1
    buffer_load_dwordx4 a[204:207], v2, s[12:15], s41 offen offset:1024 sc1
    ds_read_b64_tr_b16 v[52:53], v14 offset:8192
    ds_read_b64_tr_b16 v[54:55], v14 offset:8704
    ds_read_b64_tr_b16 v[56:57], v17 offset:8192
    ds_read_b64_tr_b16 v[58:59], v17 offset:8704
    s_waitcnt vmcnt(12)
    s_waitcnt lgkmcnt(4)
    v_mfma_f32_32x32x16_bf16 v[72:87], v[44:47], a[160:163], v[72:87]
    v_mfma_f32_32x32x16_bf16 v[104:119], v[44:47], a[164:167], v[104:119]
    v_mfma_f32_32x32x16_bf16 v[88:103], v[48:51], a[160:163], v[88:103]
    v_mfma_f32_32x32x16_bf16 v[120:135], v[48:51], a[164:167], v[120:135]
    buffer_load_dwordx4 a[208:211], v2, s[12:15], s40 offen offset:2048 sc1
    buffer_load_dwordx4 a[212:215], v2, s[12:15], s41 offen offset:2048 sc1
    s_barrier
    ds_read_b64_tr_b16 v[44:45], v14 offset:16384
    ds_read_b64_tr_b16 v[46:47], v14 offset:16896
    ds_read_b64_tr_b16 v[48:49], v17 offset:16384
    ds_read_b64_tr_b16 v[50:51], v17 offset:16896
    s_waitcnt vmcnt(12)
    s_waitcnt lgkmcnt(4)
    v_mfma_f32_32x32x16_bf16 v[72:87], v[52:55], a[168:171], v[72:87]
    v_mfma_f32_32x32x16_bf16 v[104:119], v[52:55], a[172:175], v[104:119]
    v_mfma_f32_32x32x16_bf16 v[88:103], v[56:59], a[168:171], v[88:103]
    v_mfma_f32_32x32x16_bf16 v[120:135], v[56:59], a[172:175], v[120:135]
    buffer_load_dwordx4 a[216:219], v2, s[12:15], s40 offen offset:3072 sc1
    buffer_load_dwordx4 a[220:223], v2, s[12:15], s41 offen offset:3072 sc1
    s_waitcnt vmcnt(10)
    v_lshl_add_u32 v6, v3, 2, s59
    v_add_u32 v6, 0x10000, v6
    ds_read_b32 v200, v6 offset:0
    ds_read_b32 v201, v6 offset:128
    ds_read_b32 v202, v6 offset:256
    ds_read_b32 v203, v6 offset:384
    ds_read_b64_tr_b16 v[52:53], v14 offset:24576
    ds_read_b64_tr_b16 v[54:55], v14 offset:25088
    ds_read_b64_tr_b16 v[56:57], v17 offset:24576
    ds_read_b64_tr_b16 v[58:59], v17 offset:25088
    s_waitcnt lgkmcnt(4)
    v_mfma_f32_32x32x16_bf16 v[72:87], v[44:47], a[176:179], v[72:87]
    v_mfma_f32_32x32x16_bf16 v[104:119], v[44:47], a[180:183], v[104:119]
    v_mfma_f32_32x32x16_bf16 v[88:103], v[48:51], a[176:179], v[88:103]
    v_mfma_f32_32x32x16_bf16 v[120:135], v[48:51], a[180:183], v[120:135]
    s_xor_b32 s4, s3, 1
    s_mul_i32 s4, s4, 0x3000
    s_add_u32 s4, s4, 0x12000
    v_add_u32 v24, s4, v2
    s_xor_b32 s4, s3, 2
    s_mul_i32 s4, s4, 0x3000
    s_add_u32 s4, s4, 0x13000
    v_add_u32 v25, s4, v2
    s_xor_b32 s4, s3, 3
    s_mul_i32 s4, s4, 0x3000
    s_add_u32 s4, s4, 0x14000
    v_add_u32 v26, s4, v2
    s_mul_i32 s4, s3, 0x3000
    s_add_u32 s4, s4, 0x12000
    v_add_u32 v27, s4, v2
    ds_read_b32 v204, v6 offset:512
    ds_read_b32 v205, v6 offset:640
    ds_read_b32 v206, v6 offset:768
    ds_read_b32 v207, v6 offset:896
    ds_read_b64_tr_b16 v[44:45], v14 offset:32768
    ds_read_b64_tr_b16 v[46:47], v14 offset:33280
    ds_read_b64_tr_b16 v[48:49], v17 offset:32768
    ds_read_b64_tr_b16 v[50:51], v17 offset:33280
    s_waitcnt vmcnt(8)
    s_waitcnt lgkmcnt(4)
    v_mfma_f32_32x32x16_bf16 v[72:87], v[52:55], a[184:187], v[72:87]
    v_mfma_f32_32x32x16_bf16 v[104:119], v[52:55], a[188:191], v[104:119]
    v_mfma_f32_32x32x16_bf16 v[88:103], v[56:59], a[184:187], v[88:103]
    v_mfma_f32_32x32x16_bf16 v[120:135], v[56:59], a[188:191], v[120:135]
    s_lshl_b32 s6, s38, 2
    v_lshlrev_b32 v5, 1, v4
    v_add_u32 v5, s6, v5
    v_and_b32 v7, 7, v3
    v_xor_b32 v5, v5, v7
    v_lshlrev_b32 v5, 4, v5
    v_lshl_add_u32 v5, v3, 7, v5
    s_lshl_b32 s6, s39, 12
    s_add_u32 s6, s6, 0x1e000
    v_add_u32 v28, s6, v5
    v_xor_b32 v29, 16, v28
    ds_read_b32 v208, v6 offset:1024
    ds_read_b32 v209, v6 offset:1152
    ds_read_b32 v210, v6 offset:1280
    ds_read_b32 v211, v6 offset:1408
    ds_read_b64_tr_b16 v[52:53], v14 offset:40960
    ds_read_b64_tr_b16 v[54:55], v14 offset:41472
    ds_read_b64_tr_b16 v[56:57], v17 offset:40960
    ds_read_b64_tr_b16 v[58:59], v17 offset:41472
    s_waitcnt vmcnt(6)
    s_waitcnt lgkmcnt(4)
    v_mfma_f32_32x32x16_bf16 v[72:87], v[44:47], a[192:195], v[72:87]
    v_mfma_f32_32x32x16_bf16 v[104:119], v[44:47], a[196:199], v[104:119]
    v_mfma_f32_32x32x16_bf16 v[88:103], v[48:51], a[192:195], v[88:103]
    v_mfma_f32_32x32x16_bf16 v[120:135], v[48:51], a[196:199], v[120:135]
    ds_read_b32 v212, v6 offset:1536
    ds_read_b32 v213, v6 offset:1664
    ds_read_b32 v214, v6 offset:1792
    ds_read_b32 v215, v6 offset:1920
    ds_read_b64_tr_b16 v[44:45], v14 offset:49152
    ds_read_b64_tr_b16 v[46:47], v14 offset:49664
    ds_read_b64_tr_b16 v[48:49], v17 offset:49152
    ds_read_b64_tr_b16 v[50:51], v17 offset:49664
    s_waitcnt vmcnt(4)
    s_waitcnt lgkmcnt(4)
    v_mfma_f32_32x32x16_bf16 v[72:87], v[52:55], a[200:203], v[72:87]
    v_mfma_f32_32x32x16_bf16 v[104:119], v[52:55], a[204:207], v[104:119]
    v_mfma_f32_32x32x16_bf16 v[88:103], v[56:59], a[200:203], v[88:103]
    v_mfma_f32_32x32x16_bf16 v[120:135], v[56:59], a[204:207], v[120:135]
    v_lshrrev_b32 v7, 3, v1
    v_and_b32 v8, 7, v1
    v_xor_b32 v10, v7, v8
    v_lshlrev_b32 v10, 4, v10
    v_lshl_add_u32 v10, v7, 7, v10
    s_lshl_b32 s6, s3, 11
    s_add_u32 s6, s6, 0x1e000
    v_add_u32 v30, s6, v10
    s_lshl_b32 s4, s56, 6
    s_lshl_b32 s5, s3, 4
    s_add_u32 s4, s4, s5
    v_add_u32 v11, s4, v7
    v_lshlrev_b32 v11, 10, v11
    v_lshl_add_u32 v31, v8, 4, v11
    s_lshl_b32 s44, s57, 7
    s_add_u32 s45, s44, 0x2000
    ds_read_b64_tr_b16 v[52:53], v14 offset:57344
    ds_read_b64_tr_b16 v[54:55], v14 offset:57856
    ds_read_b64_tr_b16 v[56:57], v17 offset:57344
    ds_read_b64_tr_b16 v[58:59], v17 offset:57856
    s_waitcnt vmcnt(2)
    s_waitcnt lgkmcnt(4)
    v_mfma_f32_32x32x16_bf16 v[72:87], v[44:47], a[208:211], v[72:87]
    v_mfma_f32_32x32x16_bf16 v[104:119], v[44:47], a[212:215], v[104:119]
    v_mfma_f32_32x32x16_bf16 v[88:103], v[48:51], a[208:211], v[88:103]
    v_mfma_f32_32x32x16_bf16 v[120:135], v[48:51], a[212:215], v[120:135]
    v_add_f32 v200, v200, v208
    v_add_f32 v201, v201, v209
    v_add_f32 v202, v202, v210
    v_add_f32 v203, v203, v211
    v_add_f32 v204, v204, v212
    v_add_f32 v205, v205, v213
    v_add_f32 v206, v206, v214
    v_add_f32 v207, v207, v215
    v_add_f32 v200, v200, v204
    v_add_f32 v201, v201, v205
    v_add_f32 v202, v202, v206
    v_add_f32 v203, v203, v207
    v_add_f32 v200, v200, v202
    v_add_f32 v201, v201, v203
    v_add_f32 v200, v200, v201
    v_mul_f32 v200, 0x3b000000, v200
    v_add_f32 v200, 0x3727c5ac, v200
    v_rcp_f32 v247, v200
    s_waitcnt vmcnt(0)
    s_waitcnt lgkmcnt(0)
    v_mfma_f32_32x32x16_bf16 v[72:87], v[52:55], a[216:219], v[72:87]
    v_mfma_f32_32x32x16_bf16 v[104:119], v[52:55], a[220:223], v[104:119]
    v_mfma_f32_32x32x16_bf16 v[88:103], v[56:59], a[216:219], v[88:103]
    v_mfma_f32_32x32x16_bf16 v[120:135], v[56:59], a[220:223], v[120:135]
    s_nop 10
    ds_write_b128 v24, v[88:91] offset:0
    ds_write_b128 v24, v[92:95] offset:1024
    ds_write_b128 v24, v[96:99] offset:2048
    ds_write_b128 v24, v[100:103] offset:3072
    ds_write_b128 v25, v[104:107] offset:0
    ds_write_b128 v25, v[108:111] offset:1024
    ds_write_b128 v25, v[112:115] offset:2048
    ds_write_b128 v25, v[116:119] offset:3072
    ds_write_b128 v26, v[120:123] offset:0
    ds_write_b128 v26, v[124:127] offset:1024
    ds_write_b128 v26, v[128:131] offset:2048
    ds_write_b128 v26, v[132:135] offset:3072
    s_waitcnt lgkmcnt(0)
    s_barrier
    ds_read_b128 v[88:91], v27 offset:0
    ds_read_b128 v[92:95], v27 offset:1024
    ds_read_b128 v[96:99], v27 offset:2048
    ds_read_b128 v[100:103], v27 offset:3072
    ds_read_b128 v[104:107], v27 offset:4096
    ds_read_b128 v[108:111], v27 offset:5120
    ds_read_b128 v[112:115], v27 offset:6144
    ds_read_b128 v[116:119], v27 offset:7168
    ds_read_b128 v[120:123], v27 offset:8192
    ds_read_b128 v[124:127], v27 offset:9216
    ds_read_b128 v[128:131], v27 offset:10240
    ds_read_b128 v[132:135], v27 offset:11264
    s_waitcnt lgkmcnt(8)
    v_pk_add_f32 v[72:73], v[72:73], v[88:89]
    v_pk_add_f32 v[74:75], v[74:75], v[90:91]
    v_pk_add_f32 v[76:77], v[76:77], v[92:93]
    v_pk_add_f32 v[78:79], v[78:79], v[94:95]
    v_pk_add_f32 v[80:81], v[80:81], v[96:97]
    v_pk_add_f32 v[82:83], v[82:83], v[98:99]
    v_pk_add_f32 v[84:85], v[84:85], v[100:101]
    v_pk_add_f32 v[86:87], v[86:87], v[102:103]
    s_waitcnt lgkmcnt(0)
    v_pk_add_f32 v[104:105], v[104:105], v[120:121]
    v_pk_add_f32 v[106:107], v[106:107], v[122:123]
    v_pk_add_f32 v[108:109], v[108:109], v[124:125]
    v_pk_add_f32 v[110:111], v[110:111], v[126:127]
    v_pk_add_f32 v[112:113], v[112:113], v[128:129]
    v_pk_add_f32 v[114:115], v[114:115], v[130:131]
    v_pk_add_f32 v[116:117], v[116:117], v[132:133]
    v_pk_add_f32 v[118:119], v[118:119], v[134:135]
    v_pk_add_f32 v[72:73], v[72:73], v[104:105]
    v_pk_add_f32 v[74:75], v[74:75], v[106:107]
    v_pk_add_f32 v[76:77], v[76:77], v[108:109]
    v_pk_add_f32 v[78:79], v[78:79], v[110:111]
    v_pk_add_f32 v[80:81], v[80:81], v[112:113]
    v_pk_add_f32 v[82:83], v[82:83], v[114:115]
    v_pk_add_f32 v[84:85], v[84:85], v[116:117]
    v_pk_add_f32 v[86:87], v[86:87], v[118:119]
    v_fma_f32 v7, v72, v247, v224
    v_fma_f32 v8, v73, v247, v225
    v_cvt_pk_bf16_f32 v60, v7, v8
    v_fma_f32 v7, v74, v247, v226
    v_fma_f32 v8, v75, v247, v227
    v_cvt_pk_bf16_f32 v61, v7, v8
    v_fma_f32 v7, v76, v247, v228
    v_fma_f32 v8, v77, v247, v229
    v_cvt_pk_bf16_f32 v62, v7, v8
    v_fma_f32 v7, v78, v247, v230
    v_fma_f32 v8, v79, v247, v231
    v_cvt_pk_bf16_f32 v63, v7, v8
    v_fma_f32 v7, v80, v247, v232
    v_fma_f32 v8, v81, v247, v233
    v_cvt_pk_bf16_f32 v64, v7, v8
    v_fma_f32 v7, v82, v247, v234
    v_fma_f32 v8, v83, v247, v235
    v_cvt_pk_bf16_f32 v65, v7, v8
    v_fma_f32 v7, v84, v247, v236
    v_fma_f32 v8, v85, v247, v237
    v_cvt_pk_bf16_f32 v66, v7, v8
    v_fma_f32 v7, v86, v247, v238
    v_fma_f32 v8, v87, v247, v239
    v_cvt_pk_bf16_f32 v67, v7, v8
    ds_write_b128 v28, v[60:63]
    ds_write_b128 v29, v[64:67]
    s_waitcnt lgkmcnt(0)
    s_barrier
    ds_read_b128 v[60:63], v30
    ds_read_b128 v[64:67], v30 offset:1024
    s_waitcnt lgkmcnt(1)
    buffer_store_dwordx4 v[60:63], v31, s[16:19], s44 offen sc1
    s_waitcnt lgkmcnt(0)
    buffer_store_dwordx4 v[64:67], v31, s[16:19], s45 offen sc1
KEND:
    s_endpgm
.section .rodata,"a"
.p2align 6
.amdhsa_kernel sequential_preLN__spectral_gfnet__glu_gated_reglu__prompt_kernel
  .amdhsa_next_free_vgpr 512
  .amdhsa_next_free_sgpr 100
  .amdhsa_accum_offset 256
  .amdhsa_group_segment_fixed_size 0
  .amdhsa_kernarg_size 80
  .amdhsa_user_sgpr_count 2
  .amdhsa_user_sgpr_kernarg_segment_ptr 1
  .amdhsa_system_sgpr_workgroup_id_x 1
.end_amdhsa_kernel
```
